```python
import torch

def _softmax(x, axis=-1):
    return torch.softmax(x, dim=axis)
def _gelu(x):
    return torch.nn.functional.gelu(x, approximate="tanh")
def _silu(x):
    return torch.nn.functional.silu(x)
def _sigmoid(x):
    return torch.sigmoid(x)
def _layernorm(x, axis=-1, eps=1e-5):
    m = x.mean(dim=axis, keepdim=True)
    v = x.var(dim=axis, keepdim=True, unbiased=False)
    return (x - m) / torch.sqrt(v + eps)
def _scatter_add(tgt, idx, src, axis=0):
    return tgt.clone().index_add_(axis, idx, src)
def _segment_sum(src, seg, n):
    out = torch.zeros((n,) + src.shape[1:], dtype=src.dtype)
    return out.index_add_(0, seg, src)
def _pad(x, pw):
    flat = tuple(v for pair in reversed(pw) for v in pair)
    return torch.nn.functional.pad(x, flat)

kernel_name = 'standalone__gqa_softmax__sampling'

def setup_inputs():

    _w = (lambda a: (lambda t: t.to(torch.bfloat16) if t.is_floating_point() else t)(torch.as_tensor(a)))
    B, Hq, Hkv, Sq, Sk, D = 8, 32, 4, 4, 8192, 128
    return {
        "q": _w((lambda *s: torch.randn(*s, dtype=torch.bfloat16) * 0.8)(B, Hq, Sq, D)),
        "k": _w((lambda *s: torch.randn(*s, dtype=torch.bfloat16) * 0.8)(B, Hkv, Sk, D)),
        "v": _w((lambda *s: torch.randn(*s, dtype=torch.bfloat16) * 0.05)(B, Hkv, Sk, D)),
    }

def reference(q, k, v):
    B, Hq, Sq, D = q.shape
    Hkv = k.shape[1]
    rep = Hq // Hkv
    k = (lambda x, n, axis: torch.repeat_interleave(x, n, dim=axis))(k, rep, axis=1)
    v = (lambda x, n, axis: torch.repeat_interleave(x, n, dim=axis))(v, rep, axis=1)
    scale = D ** -0.5
    scores = torch.einsum("bhqd,bhkd->bhqk", q, k) * scale
    p = _softmax(scores, axis=-1)
    return torch.einsum("bhqk,bhkd->bhqd", p, v)
```

```asm
; @launch grid=(256,1,1) block=(256,1,1) lds=74752
.amdgcn_target "amdgcn-amd-amdhsa--gfx950"
.text
.globl standalone__gqa_softmax__sampling_kernel
.p2align 8
.type standalone__gqa_softmax__sampling_kernel,@function
standalone__gqa_softmax__sampling_kernel:
    s_cmp_ge_u32 s2, 256
    s_cbranch_scc1 L_end
    s_load_dwordx8 s[4:11], s[0:1], 0
    s_load_dwordx2 s[14:15], s[0:1], 40
    s_getpc_b64 s[100:101]
L_pc:
    v_min_u32 v1, (L_code_end - L_pc) / 128, v0
    v_lshlrev_b32 v1, 7, v1
    global_load_dword v47, v1, s[100:101]
    v_lshrrev_b32 v1, 6, v0
    v_and_b32 v0, 63, v0
    v_lshrrev_b32 v2, 4, v0
    v_readfirstlane_b32 s3, v1
    v_and_b32 v3, 15, v0
    v_lshlrev_b32 v4, 8, v2
    v_xor_b32 v5, v3, v2
    s_and_b32 s44, s2, 7
    s_lshl_b32 s44, s44, 2
    s_bfe_u32 s45, s2, 0x20003
    s_add_u32 s44, s44, s45
    s_lshr_b32 s45, s2, 5
    s_lshl_b32 s40, s44, 21
    s_lshl_b32 s42, s45, 18
    s_add_u32 s40, s40, s42
    s_lshl_b32 s41, s3, 12
    s_lshl_b32 s42, s3, 10
    s_add_u32 s40, s40, s42
    v_lshl_add_u32 v16, v5, 4, v4
    v_xor_b32 v17, 64, v16
    v_xor_b32 v18, 0x80, v16
    v_xor_b32 v19, 0xc0, v16
    v_add_u32 v17, 3072, v17
    v_add_u32 v18, 6144, v18
    v_add_u32 v19, 9216, v19
    s_mov_b32 m0, s41
    s_mov_b32 s18, 0x4000000
    s_mov_b32 s19, 0x20000
    s_waitcnt lgkmcnt(0)
    s_mov_b32 s16, s6
    s_and_b32 s17, s7, 0xffff
    s_mov_b32 s47, s40
    buffer_load_dwordx4 v16, s[16:19], s47 offen offset:0 nt lds
    buffer_load_dwordx4 v17, s[16:19], s47 offen offset:1024 nt lds
    buffer_load_dwordx4 v18, s[16:19], s47 offen offset:2048 nt lds
    buffer_load_dwordx4 v19, s[16:19], s47 offen offset:3072 nt lds
    s_mov_b32 s24, s4
    s_and_b32 s25, s5, 0xffff
    s_mov_b32 s26, 0x40000
    s_mov_b32 s27, 0x20000
    s_and_b32 s42, s3, 1
    s_lshl_b32 s42, s42, 7
    v_xor_b32 v21, s42, v16
    v_xor_b32 v22, 64, v21
    s_lshl_b32 s42, s3, 11
    s_add_u32 m0, s42, 65536
    s_lshl_b32 s43, s44, 13
    s_add_u32 s42, s42, s43
    buffer_load_dwordx4 v21, s[24:27], s42 offen lds
    buffer_load_dwordx4 v22, s[24:27], s42 offen offset:1024 lds
    s_mul_i32 s53, s44, 82176
    s_add_u32 s53, s53, 81920
    s_load_dword s52, s[14:15], s53
    s_add_u32 m0, s41, 16384
    s_add_u32 s47, s40, 16384
    buffer_load_dwordx4 v16, s[16:19], s47 offen offset:0 nt lds
    buffer_load_dwordx4 v17, s[16:19], s47 offen offset:1024 nt lds
    buffer_load_dwordx4 v18, s[16:19], s47 offen offset:2048 nt lds
    buffer_load_dwordx4 v19, s[16:19], s47 offen offset:3072 nt lds
    s_mov_b32 s20, s8
    s_and_b32 s21, s9, 0xffff
    s_mov_b32 s22, 0x4000000
    s_mov_b32 s23, 0x20000
    s_mov_b32 s28, s14
    s_and_b32 s29, s15, 0xffff
    s_mov_b32 s30, 0x10000000
    s_mov_b32 s31, 0x20000
    s_mov_b32 s32, s10
    s_and_b32 s33, s11, 0xffff
    s_mov_b32 s34, 0x40000
    s_mov_b32 s35, 0x20000
    v_lshlrev_b32 v6, 2, v2
    v_xor_b32 v6, v6, v3
    v_lshl_add_u32 v20, v6, 4, v4
    v_add_u32 v50, 3072, v20
    v_add_u32 v51, 6144, v20
    v_add_u32 v22, 9216, v20
    v_lshrrev_b32 v6, 5, v0
    v_xor_b32 v7, v6, v3
    v_lshlrev_b32 v7, 4, v7
    v_lshl_add_u32 v7, v3, 8, v7
    v_bfe_u32 v8, v0, 4, 1
    v_lshl_add_u32 v9, v8, 12, v7
    v_add_u32 v9, 65536, v9
    v_lshl_add_u32 v7, v8, 14, v7
    v_add_u32 v24, s41, v7
    v_xor_b32 v25, 32, v24
    v_xor_b32 v26, 64, v24
    v_xor_b32 v27, 96, v24
    v_xor_b32 v28, 128, v24
    v_xor_b32 v29, 160, v24
    v_xor_b32 v30, 192, v24
    v_xor_b32 v31, 224, v24
    v_bfe_u32 v10, v0, 2, 2
    v_lshl_add_u32 v11, v6, 2, v10
    v_lshlrev_b32 v11, 8, v11
    v_xor_b32 v10, s3, v10
    v_lshl_add_u32 v11, v10, 6, v11
    v_lshl_add_u32 v11, v8, 5, v11
    v_and_b32 v10, 3, v0
    v_lshl_add_u32 v40, v10, 3, v11
    v_lshlrev_b32 v10, 4, v0
    v_add_u32 v43, 65536, v10
    s_lshl_b32 s42, s3, 10
    v_add_u32 v42, s42, v43
    v_and_b32 v10, 31, v0
    v_lshlrev_b32 v10, 4, v10
    v_add_u32 v45, 73728, v10
    s_lshl_b32 s42, s3, 2
    v_add_u32 v44, s42, v45
    s_mov_b32 s58, 0x3fb8aa3b
    s_mov_b32 s59, s58
    s_mov_b32 s60, 0x3db504f3
    s_mov_b32 s61, s60
    v_mov_b32 v48, 0
    v_mov_b32 v49, 0
    s_waitcnt vmcnt(9)
    s_add_u32 m0, s41, 32768
    s_add_u32 s47, s40, 32768
    buffer_load_dwordx4 v16, s[16:19], s47 offen offset:0 nt lds
    s_waitcnt vmcnt(9)
    buffer_load_dwordx4 v17, s[16:19], s47 offen offset:1024 nt lds
    s_waitcnt vmcnt(9)
    buffer_load_dwordx4 v18, s[16:19], s47 offen offset:2048 nt lds
    s_waitcnt vmcnt(9)
    buffer_load_dwordx4 v19, s[16:19], s47 offen offset:3072 nt lds
    s_waitcnt vmcnt(7)
    s_add_u32 m0, s41, 49152
    s_add_u32 s47, s40, 49152
    buffer_load_dwordx4 v16, s[16:19], s47 offen offset:0 nt lds
    s_waitcnt vmcnt(7)
    buffer_load_dwordx4 v17, s[16:19], s47 offen offset:1024 nt lds
    s_waitcnt vmcnt(7)
    buffer_load_dwordx4 v18, s[16:19], s47 offen offset:2048 nt lds
    s_waitcnt vmcnt(11) lgkmcnt(0)
    s_barrier
    ds_read_b128 v[64:67], v9
    v_xor_b32 v10, 32, v9
    ds_read_b128 v[68:71], v10
    v_xor_b32 v10, 64, v9
    ds_read_b128 v[72:75], v10
    v_xor_b32 v10, 96, v9
    ds_read_b128 v[76:79], v10
    v_xor_b32 v10, 128, v9
    ds_read_b128 v[80:83], v10
    v_xor_b32 v10, 160, v9
    ds_read_b128 v[84:87], v10
    v_xor_b32 v10, 192, v9
    ds_read_b128 v[88:91], v10
    v_xor_b32 v10, 224, v9
    ds_read_b128 v[92:95], v10
    s_waitcnt vmcnt(7)
    buffer_load_dwordx4 v19, s[16:19], s47 offen offset:3072 nt lds
    ds_read_b128 v[96:99], v24 offset:0
    ds_read_b128 v[100:103], v25 offset:0
    ds_read_b128 v[104:107], v26 offset:0
    ds_read_b128 v[108:111], v27 offset:0
    ds_read_b128 v[112:115], v28 offset:0
    ds_read_b128 v[116:119], v29 offset:0
    ds_read_b128 v[120:123], v30 offset:0
    ds_read_b128 v[124:127], v31 offset:0
    s_waitcnt lgkmcnt(0)
    v_mfma_f32_32x32x16_bf16 v[128:143], v[96:99], v[64:67], 0
    s_waitcnt vmcnt(7)
    s_add_u32 m0, s41, 0
    s_add_u32 s47, s40, 65536
    buffer_load_dwordx4 v16, s[16:19], s47 offen offset:0 nt lds
    v_mfma_f32_32x32x16_bf16 v[128:143], v[100:103], v[68:71], v[128:143]
    s_waitcnt vmcnt(7)
    buffer_load_dwordx4 v17, s[16:19], s47 offen offset:1024 nt lds
    v_mfma_f32_32x32x16_bf16 v[128:143], v[104:107], v[72:75], v[128:143]
    s_waitcnt vmcnt(7)
    buffer_load_dwordx4 v18, s[16:19], s47 offen offset:2048 nt lds
    v_mfma_f32_32x32x16_bf16 v[128:143], v[108:111], v[76:79], v[128:143]
    s_waitcnt vmcnt(7)
    buffer_load_dwordx4 v19, s[16:19], s47 offen offset:3072 nt lds
    v_mfma_f32_32x32x16_bf16 v[128:143], v[112:115], v[80:83], v[128:143]
    s_waitcnt vmcnt(7)
    s_add_u32 m0, s41, 16384
    s_add_u32 s47, s40, 81920
    buffer_load_dwordx4 v16, s[16:19], s47 offen offset:0 nt lds
    v_mfma_f32_32x32x16_bf16 v[128:143], v[116:119], v[84:87], v[128:143]
    s_waitcnt vmcnt(7)
    buffer_load_dwordx4 v17, s[16:19], s47 offen offset:1024 nt lds
    v_mfma_f32_32x32x16_bf16 v[128:143], v[120:123], v[88:91], v[128:143]
    s_waitcnt vmcnt(7)
    buffer_load_dwordx4 v18, s[16:19], s47 offen offset:2048 nt lds
    v_mfma_f32_32x32x16_bf16 v[128:143], v[124:127], v[92:95], v[128:143]
    s_xor_b32 s54, s52, 0x9e3779b9
    s_lshr_b32 s42, s54, 16
    s_xor_b32 s54, s54, s42
    s_mul_i32 s54, s54, 0x85ebca6b
    s_lshr_b32 s42, s54, 13
    s_xor_b32 s54, s54, s42
    s_mul_i32 s54, s54, 0xc2b2ae35
    s_lshr_b32 s42, s54, 16
    s_xor_b32 s54, s54, s42
    s_xor_b32 s62, s52, 0x7f4a7c15
    s_lshr_b32 s42, s62, 16
    s_xor_b32 s62, s62, s42
    s_mul_i32 s62, s62, 0x85ebca6b
    s_lshr_b32 s42, s62, 13
    s_xor_b32 s62, s62, s42
    s_mul_i32 s62, s62, 0xc2b2ae35
    s_lshr_b32 s42, s62, 16
    s_xor_b32 s62, s62, s42
    s_xor_b32 s63, s52, 0x3c6ef372
    s_lshr_b32 s42, s63, 16
    s_xor_b32 s63, s63, s42
    s_mul_i32 s63, s63, 0x85ebca6b
    s_lshr_b32 s42, s63, 13
    s_xor_b32 s63, s63, s42
    s_mul_i32 s63, s63, 0xc2b2ae35
    s_lshr_b32 s42, s63, 16
    s_xor_b32 s63, s63, s42
    s_or_b32 s54, s54, 1
    s_add_u32 s52, s52, 1
    s_waitcnt vmcnt(7)
    buffer_load_dwordx4 v19, s[16:19], s47 offen offset:3072 nt lds
    ds_read_b128 v[96:99], v24 offset:32768
    ds_read_b128 v[100:103], v25 offset:32768
    ds_read_b128 v[104:107], v26 offset:32768
    ds_read_b128 v[108:111], v27 offset:32768
    ds_read_b128 v[112:115], v28 offset:32768
    ds_read_b128 v[116:119], v29 offset:32768
    ds_read_b128 v[120:123], v30 offset:32768
    ds_read_b128 v[124:127], v31 offset:32768
    s_nop 3
    v_max3_f32 v46, v128, v129, v130
    v_max3_f32 v46, v46, v131, v132
    v_max3_f32 v46, v46, v133, v134
    v_max3_f32 v46, v46, v135, v136
    v_max3_f32 v46, v46, v137, v138
    v_max3_f32 v46, v46, v139, v140
    v_max3_f32 v46, v46, v141, v142
    v_max_f32 v46, v46, v143
    s_waitcnt lgkmcnt(0)
    v_mfma_f32_32x32x16_bf16 v[144:159], v[96:99], v[64:67], 0
    s_waitcnt vmcnt(7)
    s_add_u32 m0, s41, 32768
    s_add_u32 s47, s40, 98304
    buffer_load_dwordx4 v16, s[16:19], s47 offen offset:0 nt lds
    v_mfma_f32_32x32x16_bf16 v[144:159], v[100:103], v[68:71], v[144:159]
    s_waitcnt vmcnt(7)
    buffer_load_dwordx4 v17, s[16:19], s47 offen offset:1024 nt lds
    v_mfma_f32_32x32x16_bf16 v[144:159], v[104:107], v[72:75], v[144:159]
    s_waitcnt vmcnt(7)
    buffer_load_dwordx4 v18, s[16:19], s47 offen offset:2048 nt lds
    v_mfma_f32_32x32x16_bf16 v[144:159], v[108:111], v[76:79], v[144:159]
    s_waitcnt vmcnt(7)
    buffer_load_dwordx4 v19, s[16:19], s47 offen offset:3072 nt lds
    v_mfma_f32_32x32x16_bf16 v[144:159], v[112:115], v[80:83], v[144:159]
    s_waitcnt vmcnt(7)
    s_add_u32 m0, s41, 49152
    s_add_u32 s47, s40, 114688
    buffer_load_dwordx4 v16, s[16:19], s47 offen offset:0 nt lds
    v_mfma_f32_32x32x16_bf16 v[144:159], v[116:119], v[84:87], v[144:159]
    s_waitcnt vmcnt(7)
    buffer_load_dwordx4 v17, s[16:19], s47 offen offset:1024 nt lds
    v_mfma_f32_32x32x16_bf16 v[144:159], v[120:123], v[88:91], v[144:159]
    s_waitcnt vmcnt(7)
    buffer_load_dwordx4 v18, s[16:19], s47 offen offset:2048 nt lds
    v_mfma_f32_32x32x16_bf16 v[144:159], v[124:127], v[92:95], v[144:159]
    s_waitcnt vmcnt(7)
    buffer_load_dwordx4 v19, s[16:19], s47 offen offset:3072 nt lds
    ds_read_b128 v[96:99], v24 offset:0
    ds_read_b128 v[100:103], v25 offset:0
    ds_read_b128 v[104:107], v26 offset:0
    ds_read_b128 v[108:111], v27 offset:0
    ds_read_b128 v[112:115], v28 offset:0
    ds_read_b128 v[116:119], v29 offset:0
    ds_read_b128 v[120:123], v30 offset:0
    ds_read_b128 v[124:127], v31 offset:0
    s_nop 3
    v_max3_f32 v46, v46, v144, v145
    v_max3_f32 v46, v46, v146, v147
    v_max3_f32 v46, v46, v148, v149
    v_max3_f32 v46, v46, v150, v151
    v_max3_f32 v46, v46, v152, v153
    v_max3_f32 v46, v46, v154, v155
    v_max3_f32 v46, v46, v156, v157
    v_max3_f32 v46, v46, v158, v159
    s_waitcnt lgkmcnt(0)
    v_mfma_f32_32x32x16_bf16 v[160:175], v[96:99], v[64:67], 0
    s_waitcnt vmcnt(7)
    s_add_u32 m0, s41, 0
    s_add_u32 s47, s40, 131072
    buffer_load_dwordx4 v16, s[16:19], s47 offen offset:0 nt lds
    v_mfma_f32_32x32x16_bf16 v[160:175], v[100:103], v[68:71], v[160:175]
    s_waitcnt vmcnt(7)
    buffer_load_dwordx4 v17, s[16:19], s47 offen offset:1024 nt lds
    v_mfma_f32_32x32x16_bf16 v[160:175], v[104:107], v[72:75], v[160:175]
    s_waitcnt vmcnt(7)
    buffer_load_dwordx4 v18, s[16:19], s47 offen offset:2048 nt lds
    v_mfma_f32_32x32x16_bf16 v[160:175], v[108:111], v[76:79], v[160:175]
    s_waitcnt vmcnt(7)
    buffer_load_dwordx4 v19, s[16:19], s47 offen offset:3072 nt lds
    v_mfma_f32_32x32x16_bf16 v[160:175], v[112:115], v[80:83], v[160:175]
    s_waitcnt vmcnt(7)
    s_add_u32 m0, s41, 16384
    s_add_u32 s47, s40, 147456
    buffer_load_dwordx4 v16, s[16:19], s47 offen offset:0 nt lds
    v_mfma_f32_32x32x16_bf16 v[160:175], v[116:119], v[84:87], v[160:175]
    s_waitcnt vmcnt(7)
    buffer_load_dwordx4 v17, s[16:19], s47 offen offset:1024 nt lds
    v_mfma_f32_32x32x16_bf16 v[160:175], v[120:123], v[88:91], v[160:175]
    s_waitcnt vmcnt(7)
    buffer_load_dwordx4 v18, s[16:19], s47 offen offset:2048 nt lds
    v_mfma_f32_32x32x16_bf16 v[160:175], v[124:127], v[92:95], v[160:175]
    s_waitcnt vmcnt(7)
    buffer_load_dwordx4 v19, s[16:19], s47 offen offset:3072 nt lds
    ds_read_b128 v[96:99], v24 offset:32768
    ds_read_b128 v[100:103], v25 offset:32768
    ds_read_b128 v[104:107], v26 offset:32768
    ds_read_b128 v[108:111], v27 offset:32768
    ds_read_b128 v[112:115], v28 offset:32768
    ds_read_b128 v[116:119], v29 offset:32768
    ds_read_b128 v[120:123], v30 offset:32768
    ds_read_b128 v[124:127], v31 offset:32768
    s_nop 3
    v_max3_f32 v46, v46, v160, v161
    v_max3_f32 v46, v46, v162, v163
    v_max3_f32 v46, v46, v164, v165
    v_max3_f32 v46, v46, v166, v167
    v_max3_f32 v46, v46, v168, v169
    v_max3_f32 v46, v46, v170, v171
    v_max3_f32 v46, v46, v172, v173
    v_max3_f32 v46, v46, v174, v175
    s_waitcnt lgkmcnt(0)
    v_mfma_f32_32x32x16_bf16 v[176:191], v[96:99], v[64:67], 0
    s_waitcnt vmcnt(7)
    s_add_u32 m0, s41, 32768
    s_add_u32 s47, s40, 163840
    buffer_load_dwordx4 v16, s[16:19], s47 offen offset:0 nt lds
    v_mfma_f32_32x32x16_bf16 v[176:191], v[100:103], v[68:71], v[176:191]
    s_waitcnt vmcnt(7)
    buffer_load_dwordx4 v17, s[16:19], s47 offen offset:1024 nt lds
    v_mfma_f32_32x32x16_bf16 v[176:191], v[104:107], v[72:75], v[176:191]
    s_waitcnt vmcnt(7)
    buffer_load_dwordx4 v18, s[16:19], s47 offen offset:2048 nt lds
    v_mfma_f32_32x32x16_bf16 v[176:191], v[108:111], v[76:79], v[176:191]
    s_waitcnt vmcnt(7)
    buffer_load_dwordx4 v19, s[16:19], s47 offen offset:3072 nt lds
    v_mfma_f32_32x32x16_bf16 v[176:191], v[112:115], v[80:83], v[176:191]
    s_waitcnt vmcnt(7)
    s_add_u32 m0, s41, 49152
    s_add_u32 s47, s40, 180224
    buffer_load_dwordx4 v16, s[16:19], s47 offen offset:0 nt lds
    v_mfma_f32_32x32x16_bf16 v[176:191], v[116:119], v[84:87], v[176:191]
    s_waitcnt vmcnt(7)
    buffer_load_dwordx4 v17, s[16:19], s47 offen offset:1024 nt lds
    v_mfma_f32_32x32x16_bf16 v[176:191], v[120:123], v[88:91], v[176:191]
    s_waitcnt vmcnt(7)
    buffer_load_dwordx4 v18, s[16:19], s47 offen offset:2048 nt lds
    v_mfma_f32_32x32x16_bf16 v[176:191], v[124:127], v[92:95], v[176:191]
    s_waitcnt vmcnt(7)
    buffer_load_dwordx4 v19, s[16:19], s47 offen offset:3072 nt lds
    ds_read_b128 v[96:99], v24 offset:0
    ds_read_b128 v[100:103], v25 offset:0
    ds_read_b128 v[104:107], v26 offset:0
    ds_read_b128 v[108:111], v27 offset:0
    ds_read_b128 v[112:115], v28 offset:0
    ds_read_b128 v[116:119], v29 offset:0
    ds_read_b128 v[120:123], v30 offset:0
    ds_read_b128 v[124:127], v31 offset:0
    s_nop 3
    v_max3_f32 v46, v46, v176, v177
    v_max3_f32 v46, v46, v178, v179
    v_max3_f32 v46, v46, v180, v181
    v_max3_f32 v46, v46, v182, v183
    v_max3_f32 v46, v46, v184, v185
    v_max3_f32 v46, v46, v186, v187
    v_max3_f32 v46, v46, v188, v189
    v_max3_f32 v46, v46, v190, v191
    s_waitcnt lgkmcnt(0)
    v_mfma_f32_32x32x16_bf16 v[192:207], v[96:99], v[64:67], 0
    s_waitcnt vmcnt(7)
    s_add_u32 m0, s41, 0
    s_add_u32 s47, s40, 196608
    buffer_load_dwordx4 v16, s[16:19], s47 offen offset:0 nt lds
    v_mfma_f32_32x32x16_bf16 v[192:207], v[100:103], v[68:71], v[192:207]
    s_waitcnt vmcnt(7)
    buffer_load_dwordx4 v17, s[16:19], s47 offen offset:1024 nt lds
    v_mfma_f32_32x32x16_bf16 v[192:207], v[104:107], v[72:75], v[192:207]
    s_waitcnt vmcnt(7)
    buffer_load_dwordx4 v18, s[16:19], s47 offen offset:2048 nt lds
    v_mfma_f32_32x32x16_bf16 v[192:207], v[108:111], v[76:79], v[192:207]
    s_waitcnt vmcnt(7)
    buffer_load_dwordx4 v19, s[16:19], s47 offen offset:3072 nt lds
    v_mfma_f32_32x32x16_bf16 v[192:207], v[112:115], v[80:83], v[192:207]
    s_waitcnt vmcnt(7)
    s_add_u32 m0, s41, 16384
    s_add_u32 s47, s40, 212992
    buffer_load_dwordx4 v16, s[16:19], s47 offen offset:0 nt lds
    v_mfma_f32_32x32x16_bf16 v[192:207], v[116:119], v[84:87], v[192:207]
    s_waitcnt vmcnt(7)
    buffer_load_dwordx4 v17, s[16:19], s47 offen offset:1024 nt lds
    v_mfma_f32_32x32x16_bf16 v[192:207], v[120:123], v[88:91], v[192:207]
    s_waitcnt vmcnt(7)
    buffer_load_dwordx4 v18, s[16:19], s47 offen offset:2048 nt lds
    v_mfma_f32_32x32x16_bf16 v[192:207], v[124:127], v[92:95], v[192:207]
    s_waitcnt vmcnt(7)
    buffer_load_dwordx4 v19, s[16:19], s47 offen offset:3072 nt lds
    ds_read_b128 v[96:99], v24 offset:32768
    ds_read_b128 v[100:103], v25 offset:32768
    ds_read_b128 v[104:107], v26 offset:32768
    ds_read_b128 v[108:111], v27 offset:32768
    ds_read_b128 v[112:115], v28 offset:32768
    ds_read_b128 v[116:119], v29 offset:32768
    ds_read_b128 v[120:123], v30 offset:32768
    ds_read_b128 v[124:127], v31 offset:32768
    s_nop 3
    v_max3_f32 v46, v46, v192, v193
    v_max3_f32 v46, v46, v194, v195
    v_max3_f32 v46, v46, v196, v197
    v_max3_f32 v46, v46, v198, v199
    v_max3_f32 v46, v46, v200, v201
    v_max3_f32 v46, v46, v202, v203
    v_max3_f32 v46, v46, v204, v205
    v_max3_f32 v46, v46, v206, v207
    s_waitcnt lgkmcnt(0)
    v_mfma_f32_32x32x16_bf16 v[208:223], v[96:99], v[64:67], 0
    s_waitcnt vmcnt(7)
    s_add_u32 m0, s41, 32768
    s_add_u32 s47, s40, 229376
    buffer_load_dwordx4 v16, s[16:19], s47 offen offset:0 nt lds
    v_mfma_f32_32x32x16_bf16 v[208:223], v[100:103], v[68:71], v[208:223]
    s_waitcnt vmcnt(7)
    buffer_load_dwordx4 v17, s[16:19], s47 offen offset:1024 nt lds
    v_mfma_f32_32x32x16_bf16 v[208:223], v[104:107], v[72:75], v[208:223]
    s_waitcnt vmcnt(7)
    buffer_load_dwordx4 v18, s[16:19], s47 offen offset:2048 nt lds
    v_mfma_f32_32x32x16_bf16 v[208:223], v[108:111], v[76:79], v[208:223]
    s_waitcnt vmcnt(7)
    buffer_load_dwordx4 v19, s[16:19], s47 offen offset:3072 nt lds
    v_mfma_f32_32x32x16_bf16 v[208:223], v[112:115], v[80:83], v[208:223]
    s_waitcnt vmcnt(7)
    s_add_u32 m0, s41, 49152
    s_add_u32 s47, s40, 245760
    buffer_load_dwordx4 v16, s[16:19], s47 offen offset:0 nt lds
    v_mfma_f32_32x32x16_bf16 v[208:223], v[116:119], v[84:87], v[208:223]
    s_waitcnt vmcnt(7)
    buffer_load_dwordx4 v17, s[16:19], s47 offen offset:1024 nt lds
    v_mfma_f32_32x32x16_bf16 v[208:223], v[120:123], v[88:91], v[208:223]
    s_waitcnt vmcnt(7)
    buffer_load_dwordx4 v18, s[16:19], s47 offen offset:2048 nt lds
    v_mfma_f32_32x32x16_bf16 v[208:223], v[124:127], v[92:95], v[208:223]
    v_bfe_u32 v1, v0, 2, 3
    v_and_b32 v2, 3, v0
    v_lshrrev_b32 v3, 5, v0
    v_lshl_add_u32 v2, v2, 1, v3
    v_mul_u32_u24 v5, 10240, v1
    v_cmp_eq_u32 vcc, s45, v1
    v_mov_b32 v4, 0x40000000
    s_mul_i32 s50, s44, 82176
    s_mul_i32 s42, s3, 2560
    v_cndmask_b32 v5, v5, v4, vcc
    v_lshl_add_u32 v8, v2, 4, v5
    v_lshl_add_u32 v9, v2, 3, v5
    s_add_u32 s46, s50, s42
    s_lshl_b32 s42, s45, 8
    s_add_u32 s50, s46, s42
    s_lshl_b32 s42, s45, 6
    s_add_u32 s51, s46, s42
    s_mul_i32 s42, s45, 10240
    s_add_u32 s46, s46, s42
    v_lshrrev_b32 v1, 3, v0
    v_and_b32 v2, 7, v0
    v_lshlrev_b32 v10, 8, v1
    v_lshl_add_u32 v10, v2, 4, v10
    v_lshlrev_b32 v11, 3, v0
    s_add_u32 s42, s41, 32768
    v_lshl_add_u32 v12, v0, 4, s42
    v_lshl_add_u32 v13, v0, 3, s42
    v_and_b32 v3, 1, v0
    v_bfe_u32 v4, v0, 1, 2
    v_lshl_add_u32 v5, v3, 5, v4
    s_lshl_b32 s43, s45, 2
    v_add_u32 v5, s43, v5
    v_lshl_add_u32 v14, v5, 4, s42
    v_lshl_add_u32 v15, v5, 3, s42
    v_lshlrev_b32 v23, 8, v4
    v_lshl_add_u32 v23, v3, 3, v23
    v_lshrrev_b32 v5, 4, v0
    v_lshl_add_u32 v23, v5, 4, v23
    v_bfe_u32 v5, v0, 3, 1
    v_lshl_add_u32 v23, v5, 2, v23
    s_lshl_b32 s48, s44, 3
    s_add_u32 s48, s48, s45
    s_lshl_b32 s48, s48, 10
    s_lshl_b32 s42, s3, 6
    s_add_u32 s48, s48, s42
    s_lshl_b32 s42, s45, 3
    s_bfm_b64 s[36:37], 8, s42
    s_mov_b32 s38, 0
    s_mov_b32 s39, -1
    s_mov_b32 s56, 0xff00ff00
    s_mov_b32 s57, s56
    s_mov_b32 s55, 8000000
    s_waitcnt vmcnt(7)
    buffer_load_dwordx4 v19, s[16:19], s47 offen offset:3072 nt lds
    ds_read_b128 v[96:99], v24 offset:0
    ds_read_b128 v[100:103], v25 offset:0
    ds_read_b128 v[104:107], v26 offset:0
    ds_read_b128 v[108:111], v27 offset:0
    ds_read_b128 v[112:115], v28 offset:0
    ds_read_b128 v[116:119], v29 offset:0
    ds_read_b128 v[120:123], v30 offset:0
    ds_read_b128 v[124:127], v31 offset:0
    s_nop 3
    v_max3_f32 v46, v46, v208, v209
    v_max3_f32 v46, v46, v210, v211
    v_max3_f32 v46, v46, v212, v213
    v_max3_f32 v46, v46, v214, v215
    v_max3_f32 v46, v46, v216, v217
    v_max3_f32 v46, v46, v218, v219
    v_max3_f32 v46, v46, v220, v221
    v_max3_f32 v46, v46, v222, v223
    s_waitcnt lgkmcnt(0)
    v_mfma_f32_32x32x16_bf16 v[224:239], v[96:99], v[64:67], 0
    s_waitcnt vmcnt(7)
    s_add_u32 m0, s41, 0
    s_add_u32 s47, s40, 0
    buffer_load_dwordx4 v20, s[20:23], s47 offen offset:0 nt lds
    v_mfma_f32_32x32x16_bf16 v[224:239], v[100:103], v[68:71], v[224:239]
    s_waitcnt vmcnt(7)
    buffer_load_dwordx4 v50, s[20:23], s47 offen offset:1024 nt lds
    v_mfma_f32_32x32x16_bf16 v[224:239], v[104:107], v[72:75], v[224:239]
    s_waitcnt vmcnt(7)
    buffer_load_dwordx4 v51, s[20:23], s47 offen offset:2048 nt lds
    v_mfma_f32_32x32x16_bf16 v[224:239], v[108:111], v[76:79], v[224:239]
    s_waitcnt vmcnt(7)
    buffer_load_dwordx4 v22, s[20:23], s47 offen offset:3072 nt lds
    v_mfma_f32_32x32x16_bf16 v[224:239], v[112:115], v[80:83], v[224:239]
    s_waitcnt vmcnt(7)
    s_add_u32 m0, s41, 16384
    s_add_u32 s47, s40, 16384
    buffer_load_dwordx4 v20, s[20:23], s47 offen offset:0 nt lds
    v_mfma_f32_32x32x16_bf16 v[224:239], v[116:119], v[84:87], v[224:239]
    s_waitcnt vmcnt(7)
    buffer_load_dwordx4 v50, s[20:23], s47 offen offset:1024 nt lds
    v_mfma_f32_32x32x16_bf16 v[224:239], v[120:123], v[88:91], v[224:239]
    s_waitcnt vmcnt(7)
    buffer_load_dwordx4 v51, s[20:23], s47 offen offset:2048 nt lds
    v_mfma_f32_32x32x16_bf16 v[224:239], v[124:127], v[92:95], v[224:239]
    s_waitcnt vmcnt(7)
    buffer_load_dwordx4 v22, s[20:23], s47 offen offset:3072 nt lds
    ds_read_b128 v[96:99], v24 offset:32768
    ds_read_b128 v[100:103], v25 offset:32768
    ds_read_b128 v[104:107], v26 offset:32768
    ds_read_b128 v[108:111], v27 offset:32768
    ds_read_b128 v[112:115], v28 offset:32768
    ds_read_b128 v[116:119], v29 offset:32768
    ds_read_b128 v[120:123], v30 offset:32768
    ds_read_b128 v[124:127], v31 offset:32768
    s_nop 3
    v_max3_f32 v46, v46, v224, v225
    v_max3_f32 v46, v46, v226, v227
    v_max3_f32 v46, v46, v228, v229
    v_max3_f32 v46, v46, v230, v231
    v_max3_f32 v46, v46, v232, v233
    v_max3_f32 v46, v46, v234, v235
    v_max3_f32 v46, v46, v236, v237
    v_max3_f32 v46, v46, v238, v239
    s_waitcnt lgkmcnt(0)
    v_mfma_f32_32x32x16_bf16 v[240:255], v[96:99], v[64:67], 0
    v_mfma_f32_32x32x16_bf16 v[240:255], v[100:103], v[68:71], v[240:255]
    v_mfma_f32_32x32x16_bf16 v[240:255], v[104:107], v[72:75], v[240:255]
    v_mfma_f32_32x32x16_bf16 v[240:255], v[108:111], v[76:79], v[240:255]
    v_mfma_f32_32x32x16_bf16 v[240:255], v[112:115], v[80:83], v[240:255]
    v_mfma_f32_32x32x16_bf16 v[240:255], v[116:119], v[84:87], v[240:255]
    v_mfma_f32_32x32x16_bf16 v[240:255], v[120:123], v[88:91], v[240:255]
    s_waitcnt vmcnt(11)
    s_add_u32 m0, s41, 32768
    s_add_u32 s47, s40, 32768
    buffer_load_dwordx4 v20, s[20:23], s47 offen offset:0 nt lds
    v_mfma_f32_32x32x16_bf16 v[240:255], v[124:127], v[92:95], v[240:255]
    s_getreg_b32 s49, hwreg(HW_REG_XCC_ID)
    s_mul_i32 s49, s49, 0x01000193
    s_xor_b32 s49, s49, s54
    s_xor_b32 s49, s49, 0x5bd1e994
    v_mov_b32 v2, s49
    v_or_b32 v1, s3, v0
    v_min_u32 v1, 1, v1
    v_lshlrev_b32 v1, 30, v1
    s_add_u32 s96, s53, 128
    s_lshl_b32 s42, s45, 2
    s_add_u32 s42, s42, s96
    buffer_store_dword v2, v1, s[28:31], s42 offen
    s_nop 1
    v_max3_f32 v46, v46, v240, v241
    v_max3_f32 v46, v46, v242, v243
    v_max3_f32 v46, v46, v244, v245
    v_max3_f32 v46, v46, v246, v247
    v_max3_f32 v46, v46, v248, v249
    v_max3_f32 v46, v46, v250, v251
    v_max3_f32 v46, v46, v252, v253
    v_max3_f32 v46, v46, v254, v255
    v_mov_b32 v1, v46
    s_nop 1
    v_permlane32_swap_b32 v1, v46
    v_max_f32 v1, v1, v46
    ds_write_b32 v44, v1
    s_waitcnt lgkmcnt(0)
    s_barrier
    ds_read_b128 v[4:7], v45
    s_waitcnt vmcnt(11)
    buffer_load_dwordx4 v50, s[20:23], s47 offen offset:1024 nt lds
    s_waitcnt lgkmcnt(0)
    v_max3_f32 v1, v4, v5, v6
    s_mov_b32 s42, 0xff7fffff
    v_max_f32 v1, v1, v7
    v_cvt_pk_bf16_f32 v1, v1, v1
    v_lshlrev_b32 v1, 16, v1
    v_mul_f32 v1, s60, v1
    v_cvt_pk_bf16_f32 v1, v1, v1
    v_lshlrev_b32 v1, 16, v1
    v_max_f32 v46, s42, v1
    v_cvt_pk_bf16_f32 v52, v128, v129
    v_cvt_pk_bf16_f32 v53, v130, v131
    v_cvt_pk_bf16_f32 v54, v132, v133
    v_cvt_pk_bf16_f32 v55, v134, v135
    v_lshlrev_b32 v56, 16, v52
    v_and_b32 v57, 0xffff0000, v52
    v_lshlrev_b32 v58, 16, v53
    v_and_b32 v59, 0xffff0000, v53
    v_lshlrev_b32 v60, 16, v54
    v_and_b32 v61, 0xffff0000, v54
    v_lshlrev_b32 v62, 16, v55
    v_and_b32 v63, 0xffff0000, v55
    v_pk_mul_f32 v[56:57], v[56:57], s[60:61]
    v_pk_mul_f32 v[58:59], v[58:59], s[60:61]
    v_pk_mul_f32 v[60:61], v[60:61], s[60:61]
    v_pk_mul_f32 v[62:63], v[62:63], s[60:61]
    v_cvt_pk_bf16_f32 v52, v56, v57
    v_cvt_pk_bf16_f32 v53, v58, v59
    v_cvt_pk_bf16_f32 v54, v60, v61
    v_cvt_pk_bf16_f32 v55, v62, v63
    v_lshlrev_b32 v56, 16, v52
    v_and_b32 v57, 0xffff0000, v52
    v_lshlrev_b32 v58, 16, v53
    v_and_b32 v59, 0xffff0000, v53
    v_lshlrev_b32 v60, 16, v54
    v_and_b32 v61, 0xffff0000, v54
    v_lshlrev_b32 v62, 16, v55
    v_and_b32 v63, 0xffff0000, v55
    v_pk_add_f32 v[56:57], v[56:57], v[46:47] op_sel_hi:[1,0] neg_lo:[0,1] neg_hi:[0,1]
    v_pk_add_f32 v[58:59], v[58:59], v[46:47] op_sel_hi:[1,0] neg_lo:[0,1] neg_hi:[0,1]
    v_pk_add_f32 v[60:61], v[60:61], v[46:47] op_sel_hi:[1,0] neg_lo:[0,1] neg_hi:[0,1]
    v_pk_add_f32 v[62:63], v[62:63], v[46:47] op_sel_hi:[1,0] neg_lo:[0,1] neg_hi:[0,1]
    v_pk_mul_f32 v[56:57], v[56:57], s[58:59]
    v_pk_mul_f32 v[58:59], v[58:59], s[58:59]
    v_pk_mul_f32 v[60:61], v[60:61], s[58:59]
    v_pk_mul_f32 v[62:63], v[62:63], s[58:59]
    v_exp_f32 v56, v56
    v_exp_f32 v57, v57
    v_exp_f32 v58, v58
    v_exp_f32 v59, v59
    v_exp_f32 v60, v60
    v_exp_f32 v61, v61
    v_exp_f32 v62, v62
    v_exp_f32 v63, v63
    v_cvt_pk_bf16_f32 v52, v56, v57
    v_cvt_pk_bf16_f32 v53, v58, v59
    v_cvt_pk_bf16_f32 v54, v60, v61
    v_cvt_pk_bf16_f32 v55, v62, v63
    v_pk_add_f32 v[56:57], v[56:57], v[58:59]
    v_pk_add_f32 v[60:61], v[60:61], v[62:63]
    v_pk_add_f32 v[48:49], v[48:49], v[56:57]
    v_pk_add_f32 v[48:49], v[48:49], v[60:61]
    ds_write_b128 v42, v[52:55] offset:0
    s_waitcnt vmcnt(11)
    buffer_load_dwordx4 v51, s[20:23], s47 offen offset:2048 nt lds
    s_waitcnt vmcnt(11)
    buffer_load_dwordx4 v22, s[20:23], s47 offen offset:3072 nt lds
    s_waitcnt vmcnt(11)
    s_add_u32 m0, s41, 49152
    s_add_u32 s47, s40, 49152
    buffer_load_dwordx4 v20, s[20:23], s47 offen offset:0 nt lds
    s_waitcnt vmcnt(11)
    buffer_load_dwordx4 v50, s[20:23], s47 offen offset:1024 nt lds
    s_waitcnt vmcnt(11)
    buffer_load_dwordx4 v51, s[20:23], s47 offen offset:2048 nt lds
    s_waitcnt vmcnt(11)
    buffer_load_dwordx4 v22, s[20:23], s47 offen offset:3072 nt lds
    s_waitcnt lgkmcnt(0)
    s_barrier
    ds_read_b128 v[112:115], v43 offset:0
    ds_read_b64_tr_b16 v[96:97], v40 offset:0
    ds_read_b64_tr_b16 v[98:99], v40 offset:2048
    ds_read_b128 v[116:119], v43 offset:1024
    ds_read_b64_tr_b16 v[100:101], v40 offset:4096
    ds_read_b64_tr_b16 v[102:103], v40 offset:6144
    ds_read_b128 v[120:123], v43 offset:2048
    ds_read_b64_tr_b16 v[104:105], v40 offset:8192
    ds_read_b64_tr_b16 v[106:107], v40 offset:10240
    ds_read_b128 v[124:127], v43 offset:3072
    ds_read_b64_tr_b16 v[108:109], v40 offset:12288
    ds_read_b64_tr_b16 v[110:111], v40 offset:14336
    s_waitcnt lgkmcnt(9)
    v_mfma_f32_32x32x16_bf16 v[64:79], v[96:99], v[112:115], 0
    s_waitcnt lgkmcnt(6)
    v_mfma_f32_32x32x16_bf16 v[64:79], v[100:103], v[116:119], v[64:79]
    s_waitcnt lgkmcnt(3)
    v_mfma_f32_32x32x16_bf16 v[64:79], v[104:107], v[120:123], v[64:79]
    s_waitcnt lgkmcnt(0)
    v_mfma_f32_32x32x16_bf16 v[64:79], v[108:111], v[124:127], v[64:79]
    v_cvt_pk_bf16_f32 v52, v136, v137
    v_cvt_pk_bf16_f32 v53, v138, v139
    v_cvt_pk_bf16_f32 v54, v140, v141
    v_cvt_pk_bf16_f32 v55, v142, v143
    v_lshlrev_b32 v56, 16, v52
    v_and_b32 v57, 0xffff0000, v52
    v_lshlrev_b32 v58, 16, v53
    v_and_b32 v59, 0xffff0000, v53
    v_lshlrev_b32 v60, 16, v54
    v_and_b32 v61, 0xffff0000, v54
    v_lshlrev_b32 v62, 16, v55
    v_and_b32 v63, 0xffff0000, v55
    v_pk_mul_f32 v[56:57], v[56:57], s[60:61]
    v_pk_mul_f32 v[58:59], v[58:59], s[60:61]
    v_pk_mul_f32 v[60:61], v[60:61], s[60:61]
    v_pk_mul_f32 v[62:63], v[62:63], s[60:61]
    v_cvt_pk_bf16_f32 v52, v56, v57
    v_cvt_pk_bf16_f32 v53, v58, v59
    v_cvt_pk_bf16_f32 v54, v60, v61
    v_cvt_pk_bf16_f32 v55, v62, v63
    v_lshlrev_b32 v56, 16, v52
    v_and_b32 v57, 0xffff0000, v52
    v_lshlrev_b32 v58, 16, v53
    v_and_b32 v59, 0xffff0000, v53
    v_lshlrev_b32 v60, 16, v54
    v_and_b32 v61, 0xffff0000, v54
    v_lshlrev_b32 v62, 16, v55
    v_and_b32 v63, 0xffff0000, v55
    v_pk_add_f32 v[56:57], v[56:57], v[46:47] op_sel_hi:[1,0] neg_lo:[0,1] neg_hi:[0,1]
    v_pk_add_f32 v[58:59], v[58:59], v[46:47] op_sel_hi:[1,0] neg_lo:[0,1] neg_hi:[0,1]
    v_pk_add_f32 v[60:61], v[60:61], v[46:47] op_sel_hi:[1,0] neg_lo:[0,1] neg_hi:[0,1]
    v_pk_add_f32 v[62:63], v[62:63], v[46:47] op_sel_hi:[1,0] neg_lo:[0,1] neg_hi:[0,1]
    v_pk_mul_f32 v[56:57], v[56:57], s[58:59]
    v_pk_mul_f32 v[58:59], v[58:59], s[58:59]
    v_pk_mul_f32 v[60:61], v[60:61], s[58:59]
    v_pk_mul_f32 v[62:63], v[62:63], s[58:59]
    v_exp_f32 v56, v56
    v_exp_f32 v57, v57
    v_exp_f32 v58, v58
    v_exp_f32 v59, v59
    v_exp_f32 v60, v60
    v_exp_f32 v61, v61
    v_exp_f32 v62, v62
    v_exp_f32 v63, v63
    v_cvt_pk_bf16_f32 v52, v56, v57
    v_cvt_pk_bf16_f32 v53, v58, v59
    v_cvt_pk_bf16_f32 v54, v60, v61
    v_cvt_pk_bf16_f32 v55, v62, v63
    v_pk_add_f32 v[56:57], v[56:57], v[58:59]
    v_pk_add_f32 v[60:61], v[60:61], v[62:63]
    v_pk_add_f32 v[48:49], v[48:49], v[56:57]
    v_pk_add_f32 v[48:49], v[48:49], v[60:61]
    ds_write_b128 v42, v[52:55] offset:4096
    s_waitcnt vmcnt(8)
    s_waitcnt lgkmcnt(0)
    s_barrier
    ds_read_b128 v[112:115], v43 offset:4096
    ds_read_b64_tr_b16 v[96:97], v40 offset:16384
    ds_read_b64_tr_b16 v[98:99], v40 offset:18432
    ds_read_b128 v[116:119], v43 offset:5120
    ds_read_b64_tr_b16 v[100:101], v40 offset:20480
    ds_read_b64_tr_b16 v[102:103], v40 offset:22528
    ds_read_b128 v[120:123], v43 offset:6144
    ds_read_b64_tr_b16 v[104:105], v40 offset:24576
    ds_read_b64_tr_b16 v[106:107], v40 offset:26624
    ds_read_b128 v[124:127], v43 offset:7168
    ds_read_b64_tr_b16 v[108:109], v40 offset:28672
    ds_read_b64_tr_b16 v[110:111], v40 offset:30720
    s_waitcnt lgkmcnt(9)
    v_mfma_f32_32x32x16_bf16 v[64:79], v[96:99], v[112:115], v[64:79]
    s_waitcnt lgkmcnt(6)
    v_mfma_f32_32x32x16_bf16 v[64:79], v[100:103], v[116:119], v[64:79]
    s_waitcnt lgkmcnt(3)
    v_mfma_f32_32x32x16_bf16 v[64:79], v[104:107], v[120:123], v[64:79]
    s_waitcnt lgkmcnt(0)
    v_mfma_f32_32x32x16_bf16 v[64:79], v[108:111], v[124:127], v[64:79]
    s_waitcnt vmcnt(11)
    s_add_u32 m0, s41, 0
    s_add_u32 s47, s40, 65536
    buffer_load_dwordx4 v20, s[20:23], s47 offen offset:0 nt lds
    v_cvt_pk_bf16_f32 v52, v144, v145
    v_cvt_pk_bf16_f32 v53, v146, v147
    v_cvt_pk_bf16_f32 v54, v148, v149
    v_cvt_pk_bf16_f32 v55, v150, v151
    v_lshlrev_b32 v56, 16, v52
    v_and_b32 v57, 0xffff0000, v52
    v_lshlrev_b32 v58, 16, v53
    v_and_b32 v59, 0xffff0000, v53
    v_lshlrev_b32 v60, 16, v54
    v_and_b32 v61, 0xffff0000, v54
    v_lshlrev_b32 v62, 16, v55
    v_and_b32 v63, 0xffff0000, v55
    v_pk_mul_f32 v[56:57], v[56:57], s[60:61]
    v_pk_mul_f32 v[58:59], v[58:59], s[60:61]
    v_pk_mul_f32 v[60:61], v[60:61], s[60:61]
    v_pk_mul_f32 v[62:63], v[62:63], s[60:61]
    v_cvt_pk_bf16_f32 v52, v56, v57
    v_cvt_pk_bf16_f32 v53, v58, v59
    v_cvt_pk_bf16_f32 v54, v60, v61
    v_cvt_pk_bf16_f32 v55, v62, v63
    v_lshlrev_b32 v56, 16, v52
    v_and_b32 v57, 0xffff0000, v52
    v_lshlrev_b32 v58, 16, v53
    v_and_b32 v59, 0xffff0000, v53
    v_lshlrev_b32 v60, 16, v54
    v_and_b32 v61, 0xffff0000, v54
    v_lshlrev_b32 v62, 16, v55
    v_and_b32 v63, 0xffff0000, v55
    v_pk_add_f32 v[56:57], v[56:57], v[46:47] op_sel_hi:[1,0] neg_lo:[0,1] neg_hi:[0,1]
    v_pk_add_f32 v[58:59], v[58:59], v[46:47] op_sel_hi:[1,0] neg_lo:[0,1] neg_hi:[0,1]
    v_pk_add_f32 v[60:61], v[60:61], v[46:47] op_sel_hi:[1,0] neg_lo:[0,1] neg_hi:[0,1]
    v_pk_add_f32 v[62:63], v[62:63], v[46:47] op_sel_hi:[1,0] neg_lo:[0,1] neg_hi:[0,1]
    v_pk_mul_f32 v[56:57], v[56:57], s[58:59]
    v_pk_mul_f32 v[58:59], v[58:59], s[58:59]
    v_pk_mul_f32 v[60:61], v[60:61], s[58:59]
    v_pk_mul_f32 v[62:63], v[62:63], s[58:59]
    v_exp_f32 v56, v56
    v_exp_f32 v57, v57
    v_exp_f32 v58, v58
    v_exp_f32 v59, v59
    v_exp_f32 v60, v60
    v_exp_f32 v61, v61
    v_exp_f32 v62, v62
    v_exp_f32 v63, v63
    v_cvt_pk_bf16_f32 v52, v56, v57
    v_cvt_pk_bf16_f32 v53, v58, v59
    v_cvt_pk_bf16_f32 v54, v60, v61
    v_cvt_pk_bf16_f32 v55, v62, v63
    v_pk_add_f32 v[56:57], v[56:57], v[58:59]
    v_pk_add_f32 v[60:61], v[60:61], v[62:63]
    v_pk_add_f32 v[48:49], v[48:49], v[56:57]
    v_pk_add_f32 v[48:49], v[48:49], v[60:61]
    ds_write_b128 v42, v[52:55] offset:0
    s_waitcnt vmcnt(11)
    buffer_load_dwordx4 v50, s[20:23], s47 offen offset:1024 nt lds
    s_waitcnt vmcnt(11)
    buffer_load_dwordx4 v51, s[20:23], s47 offen offset:2048 nt lds
    s_waitcnt vmcnt(11)
    buffer_load_dwordx4 v22, s[20:23], s47 offen offset:3072 nt lds
    s_waitcnt vmcnt(8)
    s_waitcnt lgkmcnt(0)
    s_barrier
    ds_read_b128 v[112:115], v43 offset:0
    ds_read_b64_tr_b16 v[96:97], v40 offset:32768
    ds_read_b64_tr_b16 v[98:99], v40 offset:34816
    ds_read_b128 v[116:119], v43 offset:1024
    ds_read_b64_tr_b16 v[100:101], v40 offset:36864
    ds_read_b64_tr_b16 v[102:103], v40 offset:38912
    ds_read_b128 v[120:123], v43 offset:2048
    ds_read_b64_tr_b16 v[104:105], v40 offset:40960
    ds_read_b64_tr_b16 v[106:107], v40 offset:43008
    ds_read_b128 v[124:127], v43 offset:3072
    ds_read_b64_tr_b16 v[108:109], v40 offset:45056
    ds_read_b64_tr_b16 v[110:111], v40 offset:47104
    s_waitcnt lgkmcnt(9)
    v_mfma_f32_32x32x16_bf16 v[64:79], v[96:99], v[112:115], v[64:79]
    s_waitcnt lgkmcnt(6)
    v_mfma_f32_32x32x16_bf16 v[64:79], v[100:103], v[116:119], v[64:79]
    s_waitcnt lgkmcnt(3)
    v_mfma_f32_32x32x16_bf16 v[64:79], v[104:107], v[120:123], v[64:79]
    s_waitcnt lgkmcnt(0)
    v_mfma_f32_32x32x16_bf16 v[64:79], v[108:111], v[124:127], v[64:79]
    s_waitcnt vmcnt(11)
    s_add_u32 m0, s41, 16384
    s_add_u32 s47, s40, 81920
    buffer_load_dwordx4 v20, s[20:23], s47 offen offset:0 nt lds
    v_cvt_pk_bf16_f32 v52, v152, v153
    v_cvt_pk_bf16_f32 v53, v154, v155
    v_cvt_pk_bf16_f32 v54, v156, v157
    v_cvt_pk_bf16_f32 v55, v158, v159
    v_lshlrev_b32 v56, 16, v52
    v_and_b32 v57, 0xffff0000, v52
    v_lshlrev_b32 v58, 16, v53
    v_and_b32 v59, 0xffff0000, v53
    v_lshlrev_b32 v60, 16, v54
    v_and_b32 v61, 0xffff0000, v54
    v_lshlrev_b32 v62, 16, v55
    v_and_b32 v63, 0xffff0000, v55
    v_pk_mul_f32 v[56:57], v[56:57], s[60:61]
    v_pk_mul_f32 v[58:59], v[58:59], s[60:61]
    v_pk_mul_f32 v[60:61], v[60:61], s[60:61]
    v_pk_mul_f32 v[62:63], v[62:63], s[60:61]
    v_cvt_pk_bf16_f32 v52, v56, v57
    v_cvt_pk_bf16_f32 v53, v58, v59
    v_cvt_pk_bf16_f32 v54, v60, v61
    v_cvt_pk_bf16_f32 v55, v62, v63
    v_lshlrev_b32 v56, 16, v52
    v_and_b32 v57, 0xffff0000, v52
    v_lshlrev_b32 v58, 16, v53
    v_and_b32 v59, 0xffff0000, v53
    v_lshlrev_b32 v60, 16, v54
    v_and_b32 v61, 0xffff0000, v54
    v_lshlrev_b32 v62, 16, v55
    v_and_b32 v63, 0xffff0000, v55
    v_pk_add_f32 v[56:57], v[56:57], v[46:47] op_sel_hi:[1,0] neg_lo:[0,1] neg_hi:[0,1]
    v_pk_add_f32 v[58:59], v[58:59], v[46:47] op_sel_hi:[1,0] neg_lo:[0,1] neg_hi:[0,1]
    v_pk_add_f32 v[60:61], v[60:61], v[46:47] op_sel_hi:[1,0] neg_lo:[0,1] neg_hi:[0,1]
    v_pk_add_f32 v[62:63], v[62:63], v[46:47] op_sel_hi:[1,0] neg_lo:[0,1] neg_hi:[0,1]
    v_pk_mul_f32 v[56:57], v[56:57], s[58:59]
    v_pk_mul_f32 v[58:59], v[58:59], s[58:59]
    v_pk_mul_f32 v[60:61], v[60:61], s[58:59]
    v_pk_mul_f32 v[62:63], v[62:63], s[58:59]
    v_exp_f32 v56, v56
    v_exp_f32 v57, v57
    v_exp_f32 v58, v58
    v_exp_f32 v59, v59
    v_exp_f32 v60, v60
    v_exp_f32 v61, v61
    v_exp_f32 v62, v62
    v_exp_f32 v63, v63
    v_cvt_pk_bf16_f32 v52, v56, v57
    v_cvt_pk_bf16_f32 v53, v58, v59
    v_cvt_pk_bf16_f32 v54, v60, v61
    v_cvt_pk_bf16_f32 v55, v62, v63
    v_pk_add_f32 v[56:57], v[56:57], v[58:59]
    v_pk_add_f32 v[60:61], v[60:61], v[62:63]
    v_pk_add_f32 v[48:49], v[48:49], v[56:57]
    v_pk_add_f32 v[48:49], v[48:49], v[60:61]
    ds_write_b128 v42, v[52:55] offset:4096
    s_waitcnt vmcnt(11)
    buffer_load_dwordx4 v50, s[20:23], s47 offen offset:1024 nt lds
    s_waitcnt vmcnt(11)
    buffer_load_dwordx4 v51, s[20:23], s47 offen offset:2048 nt lds
    s_waitcnt vmcnt(11)
    buffer_load_dwordx4 v22, s[20:23], s47 offen offset:3072 nt lds
    s_waitcnt vmcnt(8)
    s_waitcnt lgkmcnt(0)
    s_barrier
    ds_read_b128 v[112:115], v43 offset:4096
    ds_read_b64_tr_b16 v[96:97], v40 offset:49152
    ds_read_b64_tr_b16 v[98:99], v40 offset:51200
    ds_read_b128 v[116:119], v43 offset:5120
    ds_read_b64_tr_b16 v[100:101], v40 offset:53248
    ds_read_b64_tr_b16 v[102:103], v40 offset:55296
    ds_read_b128 v[120:123], v43 offset:6144
    ds_read_b64_tr_b16 v[104:105], v40 offset:57344
    ds_read_b64_tr_b16 v[106:107], v40 offset:59392
    ds_read_b128 v[124:127], v43 offset:7168
    ds_read_b64_tr_b16 v[108:109], v40 offset:61440
    ds_read_b64_tr_b16 v[110:111], v40 offset:63488
    s_waitcnt lgkmcnt(9)
    v_mfma_f32_32x32x16_bf16 v[64:79], v[96:99], v[112:115], v[64:79]
    s_waitcnt lgkmcnt(6)
    v_mfma_f32_32x32x16_bf16 v[64:79], v[100:103], v[116:119], v[64:79]
    s_waitcnt lgkmcnt(3)
    v_mfma_f32_32x32x16_bf16 v[64:79], v[104:107], v[120:123], v[64:79]
    s_waitcnt lgkmcnt(0)
    v_mfma_f32_32x32x16_bf16 v[64:79], v[108:111], v[124:127], v[64:79]
    s_waitcnt vmcnt(11)
    s_add_u32 m0, s41, 32768
    s_add_u32 s47, s40, 98304
    buffer_load_dwordx4 v20, s[20:23], s47 offen offset:0 nt lds
    v_cvt_pk_bf16_f32 v52, v160, v161
    v_cvt_pk_bf16_f32 v53, v162, v163
    v_cvt_pk_bf16_f32 v54, v164, v165
    v_cvt_pk_bf16_f32 v55, v166, v167
    v_lshlrev_b32 v56, 16, v52
    v_and_b32 v57, 0xffff0000, v52
    v_lshlrev_b32 v58, 16, v53
    v_and_b32 v59, 0xffff0000, v53
    v_lshlrev_b32 v60, 16, v54
    v_and_b32 v61, 0xffff0000, v54
    v_lshlrev_b32 v62, 16, v55
    v_and_b32 v63, 0xffff0000, v55
    v_pk_mul_f32 v[56:57], v[56:57], s[60:61]
    v_pk_mul_f32 v[58:59], v[58:59], s[60:61]
    v_pk_mul_f32 v[60:61], v[60:61], s[60:61]
    v_pk_mul_f32 v[62:63], v[62:63], s[60:61]
    v_cvt_pk_bf16_f32 v52, v56, v57
    v_cvt_pk_bf16_f32 v53, v58, v59
    v_cvt_pk_bf16_f32 v54, v60, v61
    v_cvt_pk_bf16_f32 v55, v62, v63
    v_lshlrev_b32 v56, 16, v52
    v_and_b32 v57, 0xffff0000, v52
    v_lshlrev_b32 v58, 16, v53
    v_and_b32 v59, 0xffff0000, v53
    v_lshlrev_b32 v60, 16, v54
    v_and_b32 v61, 0xffff0000, v54
    v_lshlrev_b32 v62, 16, v55
    v_and_b32 v63, 0xffff0000, v55
    v_pk_add_f32 v[56:57], v[56:57], v[46:47] op_sel_hi:[1,0] neg_lo:[0,1] neg_hi:[0,1]
    v_pk_add_f32 v[58:59], v[58:59], v[46:47] op_sel_hi:[1,0] neg_lo:[0,1] neg_hi:[0,1]
    v_pk_add_f32 v[60:61], v[60:61], v[46:47] op_sel_hi:[1,0] neg_lo:[0,1] neg_hi:[0,1]
    v_pk_add_f32 v[62:63], v[62:63], v[46:47] op_sel_hi:[1,0] neg_lo:[0,1] neg_hi:[0,1]
    v_pk_mul_f32 v[56:57], v[56:57], s[58:59]
    v_pk_mul_f32 v[58:59], v[58:59], s[58:59]
    v_pk_mul_f32 v[60:61], v[60:61], s[58:59]
    v_pk_mul_f32 v[62:63], v[62:63], s[58:59]
    v_exp_f32 v56, v56
    v_exp_f32 v57, v57
    v_exp_f32 v58, v58
    v_exp_f32 v59, v59
    v_exp_f32 v60, v60
    v_exp_f32 v61, v61
    v_exp_f32 v62, v62
    v_exp_f32 v63, v63
    v_cvt_pk_bf16_f32 v52, v56, v57
    v_cvt_pk_bf16_f32 v53, v58, v59
    v_cvt_pk_bf16_f32 v54, v60, v61
    v_cvt_pk_bf16_f32 v55, v62, v63
    v_pk_add_f32 v[56:57], v[56:57], v[58:59]
    v_pk_add_f32 v[60:61], v[60:61], v[62:63]
    v_pk_add_f32 v[48:49], v[48:49], v[56:57]
    v_pk_add_f32 v[48:49], v[48:49], v[60:61]
    ds_write_b128 v42, v[52:55] offset:0
    s_waitcnt vmcnt(11)
    buffer_load_dwordx4 v50, s[20:23], s47 offen offset:1024 nt lds
    s_waitcnt vmcnt(11)
    buffer_load_dwordx4 v51, s[20:23], s47 offen offset:2048 nt lds
    s_waitcnt vmcnt(11)
    buffer_load_dwordx4 v22, s[20:23], s47 offen offset:3072 nt lds
    s_waitcnt vmcnt(8)
    s_waitcnt lgkmcnt(0)
    s_barrier
    ds_read_b128 v[112:115], v43 offset:0
    ds_read_b64_tr_b16 v[96:97], v40 offset:0
    ds_read_b64_tr_b16 v[98:99], v40 offset:2048
    ds_read_b128 v[116:119], v43 offset:1024
    ds_read_b64_tr_b16 v[100:101], v40 offset:4096
    ds_read_b64_tr_b16 v[102:103], v40 offset:6144
    ds_read_b128 v[120:123], v43 offset:2048
    ds_read_b64_tr_b16 v[104:105], v40 offset:8192
    ds_read_b64_tr_b16 v[106:107], v40 offset:10240
    ds_read_b128 v[124:127], v43 offset:3072
    ds_read_b64_tr_b16 v[108:109], v40 offset:12288
    ds_read_b64_tr_b16 v[110:111], v40 offset:14336
    s_waitcnt lgkmcnt(9)
    v_mfma_f32_32x32x16_bf16 v[64:79], v[96:99], v[112:115], v[64:79]
    s_waitcnt lgkmcnt(6)
    v_mfma_f32_32x32x16_bf16 v[64:79], v[100:103], v[116:119], v[64:79]
    s_waitcnt lgkmcnt(3)
    v_mfma_f32_32x32x16_bf16 v[64:79], v[104:107], v[120:123], v[64:79]
    s_waitcnt lgkmcnt(0)
    v_mfma_f32_32x32x16_bf16 v[64:79], v[108:111], v[124:127], v[64:79]
    s_waitcnt vmcnt(11)
    s_add_u32 m0, s41, 49152
    s_add_u32 s47, s40, 114688
    buffer_load_dwordx4 v20, s[20:23], s47 offen offset:0 nt lds
    v_cvt_pk_bf16_f32 v52, v168, v169
    v_cvt_pk_bf16_f32 v53, v170, v171
    v_cvt_pk_bf16_f32 v54, v172, v173
    v_cvt_pk_bf16_f32 v55, v174, v175
    v_lshlrev_b32 v56, 16, v52
    v_and_b32 v57, 0xffff0000, v52
    v_lshlrev_b32 v58, 16, v53
    v_and_b32 v59, 0xffff0000, v53
    v_lshlrev_b32 v60, 16, v54
    v_and_b32 v61, 0xffff0000, v54
    v_lshlrev_b32 v62, 16, v55
    v_and_b32 v63, 0xffff0000, v55
    v_pk_mul_f32 v[56:57], v[56:57], s[60:61]
    v_pk_mul_f32 v[58:59], v[58:59], s[60:61]
    v_pk_mul_f32 v[60:61], v[60:61], s[60:61]
    v_pk_mul_f32 v[62:63], v[62:63], s[60:61]
    v_cvt_pk_bf16_f32 v52, v56, v57
    v_cvt_pk_bf16_f32 v53, v58, v59
    v_cvt_pk_bf16_f32 v54, v60, v61
    v_cvt_pk_bf16_f32 v55, v62, v63
    v_lshlrev_b32 v56, 16, v52
    v_and_b32 v57, 0xffff0000, v52
    v_lshlrev_b32 v58, 16, v53
    v_and_b32 v59, 0xffff0000, v53
    v_lshlrev_b32 v60, 16, v54
    v_and_b32 v61, 0xffff0000, v54
    v_lshlrev_b32 v62, 16, v55
    v_and_b32 v63, 0xffff0000, v55
    v_pk_add_f32 v[56:57], v[56:57], v[46:47] op_sel_hi:[1,0] neg_lo:[0,1] neg_hi:[0,1]
    v_pk_add_f32 v[58:59], v[58:59], v[46:47] op_sel_hi:[1,0] neg_lo:[0,1] neg_hi:[0,1]
    v_pk_add_f32 v[60:61], v[60:61], v[46:47] op_sel_hi:[1,0] neg_lo:[0,1] neg_hi:[0,1]
    v_pk_add_f32 v[62:63], v[62:63], v[46:47] op_sel_hi:[1,0] neg_lo:[0,1] neg_hi:[0,1]
    v_pk_mul_f32 v[56:57], v[56:57], s[58:59]
    v_pk_mul_f32 v[58:59], v[58:59], s[58:59]
    v_pk_mul_f32 v[60:61], v[60:61], s[58:59]
    v_pk_mul_f32 v[62:63], v[62:63], s[58:59]
    v_exp_f32 v56, v56
    v_exp_f32 v57, v57
    v_exp_f32 v58, v58
    v_exp_f32 v59, v59
    v_exp_f32 v60, v60
    v_exp_f32 v61, v61
    v_exp_f32 v62, v62
    v_exp_f32 v63, v63
    v_cvt_pk_bf16_f32 v52, v56, v57
    v_cvt_pk_bf16_f32 v53, v58, v59
    v_cvt_pk_bf16_f32 v54, v60, v61
    v_cvt_pk_bf16_f32 v55, v62, v63
    v_pk_add_f32 v[56:57], v[56:57], v[58:59]
    v_pk_add_f32 v[60:61], v[60:61], v[62:63]
    v_pk_add_f32 v[48:49], v[48:49], v[56:57]
    v_pk_add_f32 v[48:49], v[48:49], v[60:61]
    ds_write_b128 v42, v[52:55] offset:4096
    s_waitcnt vmcnt(11)
    buffer_load_dwordx4 v50, s[20:23], s47 offen offset:1024 nt lds
    s_waitcnt vmcnt(11)
    buffer_load_dwordx4 v51, s[20:23], s47 offen offset:2048 nt lds
    s_waitcnt vmcnt(11)
    buffer_load_dwordx4 v22, s[20:23], s47 offen offset:3072 nt lds
    s_waitcnt vmcnt(8)
    s_waitcnt lgkmcnt(0)
    s_barrier
    ds_read_b128 v[112:115], v43 offset:4096
    ds_read_b64_tr_b16 v[96:97], v40 offset:16384
    ds_read_b64_tr_b16 v[98:99], v40 offset:18432
    ds_read_b128 v[116:119], v43 offset:5120
    ds_read_b64_tr_b16 v[100:101], v40 offset:20480
    ds_read_b64_tr_b16 v[102:103], v40 offset:22528
    ds_read_b128 v[120:123], v43 offset:6144
    ds_read_b64_tr_b16 v[104:105], v40 offset:24576
    ds_read_b64_tr_b16 v[106:107], v40 offset:26624
    ds_read_b128 v[124:127], v43 offset:7168
    ds_read_b64_tr_b16 v[108:109], v40 offset:28672
    ds_read_b64_tr_b16 v[110:111], v40 offset:30720
    s_waitcnt lgkmcnt(9)
    v_mfma_f32_32x32x16_bf16 v[64:79], v[96:99], v[112:115], v[64:79]
    s_waitcnt lgkmcnt(6)
    v_mfma_f32_32x32x16_bf16 v[64:79], v[100:103], v[116:119], v[64:79]
    s_waitcnt lgkmcnt(3)
    v_mfma_f32_32x32x16_bf16 v[64:79], v[104:107], v[120:123], v[64:79]
    s_waitcnt lgkmcnt(0)
    v_mfma_f32_32x32x16_bf16 v[64:79], v[108:111], v[124:127], v[64:79]
    s_waitcnt vmcnt(11)
    s_add_u32 m0, s41, 0
    s_add_u32 s47, s40, 131072
    buffer_load_dwordx4 v20, s[20:23], s47 offen offset:0 nt lds
    v_cvt_pk_bf16_f32 v52, v176, v177
    v_cvt_pk_bf16_f32 v53, v178, v179
    v_cvt_pk_bf16_f32 v54, v180, v181
    v_cvt_pk_bf16_f32 v55, v182, v183
    v_lshlrev_b32 v56, 16, v52
    v_and_b32 v57, 0xffff0000, v52
    v_lshlrev_b32 v58, 16, v53
    v_and_b32 v59, 0xffff0000, v53
    v_lshlrev_b32 v60, 16, v54
    v_and_b32 v61, 0xffff0000, v54
    v_lshlrev_b32 v62, 16, v55
    v_and_b32 v63, 0xffff0000, v55
    v_pk_mul_f32 v[56:57], v[56:57], s[60:61]
    v_pk_mul_f32 v[58:59], v[58:59], s[60:61]
    v_pk_mul_f32 v[60:61], v[60:61], s[60:61]
    v_pk_mul_f32 v[62:63], v[62:63], s[60:61]
    v_cvt_pk_bf16_f32 v52, v56, v57
    v_cvt_pk_bf16_f32 v53, v58, v59
    v_cvt_pk_bf16_f32 v54, v60, v61
    v_cvt_pk_bf16_f32 v55, v62, v63
    v_lshlrev_b32 v56, 16, v52
    v_and_b32 v57, 0xffff0000, v52
    v_lshlrev_b32 v58, 16, v53
    v_and_b32 v59, 0xffff0000, v53
    v_lshlrev_b32 v60, 16, v54
    v_and_b32 v61, 0xffff0000, v54
    v_lshlrev_b32 v62, 16, v55
    v_and_b32 v63, 0xffff0000, v55
    v_pk_add_f32 v[56:57], v[56:57], v[46:47] op_sel_hi:[1,0] neg_lo:[0,1] neg_hi:[0,1]
    v_pk_add_f32 v[58:59], v[58:59], v[46:47] op_sel_hi:[1,0] neg_lo:[0,1] neg_hi:[0,1]
    v_pk_add_f32 v[60:61], v[60:61], v[46:47] op_sel_hi:[1,0] neg_lo:[0,1] neg_hi:[0,1]
    v_pk_add_f32 v[62:63], v[62:63], v[46:47] op_sel_hi:[1,0] neg_lo:[0,1] neg_hi:[0,1]
    v_pk_mul_f32 v[56:57], v[56:57], s[58:59]
    v_pk_mul_f32 v[58:59], v[58:59], s[58:59]
    v_pk_mul_f32 v[60:61], v[60:61], s[58:59]
    v_pk_mul_f32 v[62:63], v[62:63], s[58:59]
    v_exp_f32 v56, v56
    v_exp_f32 v57, v57
    v_exp_f32 v58, v58
    v_exp_f32 v59, v59
    v_exp_f32 v60, v60
    v_exp_f32 v61, v61
    v_exp_f32 v62, v62
    v_exp_f32 v63, v63
    v_cvt_pk_bf16_f32 v52, v56, v57
    v_cvt_pk_bf16_f32 v53, v58, v59
    v_cvt_pk_bf16_f32 v54, v60, v61
    v_cvt_pk_bf16_f32 v55, v62, v63
    v_pk_add_f32 v[56:57], v[56:57], v[58:59]
    v_pk_add_f32 v[60:61], v[60:61], v[62:63]
    v_pk_add_f32 v[48:49], v[48:49], v[56:57]
    v_pk_add_f32 v[48:49], v[48:49], v[60:61]
    ds_write_b128 v42, v[52:55] offset:0
    s_waitcnt vmcnt(11)
    buffer_load_dwordx4 v50, s[20:23], s47 offen offset:1024 nt lds
    s_waitcnt vmcnt(11)
    buffer_load_dwordx4 v51, s[20:23], s47 offen offset:2048 nt lds
    s_waitcnt vmcnt(11)
    buffer_load_dwordx4 v22, s[20:23], s47 offen offset:3072 nt lds
    s_waitcnt vmcnt(8)
    s_waitcnt lgkmcnt(0)
    s_barrier
    ds_read_b128 v[112:115], v43 offset:0
    ds_read_b64_tr_b16 v[96:97], v40 offset:32768
    ds_read_b64_tr_b16 v[98:99], v40 offset:34816
    ds_read_b128 v[116:119], v43 offset:1024
    ds_read_b64_tr_b16 v[100:101], v40 offset:36864
    ds_read_b64_tr_b16 v[102:103], v40 offset:38912
    ds_read_b128 v[120:123], v43 offset:2048
    ds_read_b64_tr_b16 v[104:105], v40 offset:40960
    ds_read_b64_tr_b16 v[106:107], v40 offset:43008
    ds_read_b128 v[124:127], v43 offset:3072
    ds_read_b64_tr_b16 v[108:109], v40 offset:45056
    ds_read_b64_tr_b16 v[110:111], v40 offset:47104
    s_waitcnt lgkmcnt(9)
    v_mfma_f32_32x32x16_bf16 v[64:79], v[96:99], v[112:115], v[64:79]
    s_waitcnt lgkmcnt(6)
    v_mfma_f32_32x32x16_bf16 v[64:79], v[100:103], v[116:119], v[64:79]
    s_waitcnt lgkmcnt(3)
    v_mfma_f32_32x32x16_bf16 v[64:79], v[104:107], v[120:123], v[64:79]
    s_waitcnt lgkmcnt(0)
    v_mfma_f32_32x32x16_bf16 v[64:79], v[108:111], v[124:127], v[64:79]
    s_waitcnt vmcnt(11)
    s_add_u32 m0, s41, 16384
    s_add_u32 s47, s40, 147456
    buffer_load_dwordx4 v20, s[20:23], s47 offen offset:0 nt lds
    v_cvt_pk_bf16_f32 v52, v184, v185
    v_cvt_pk_bf16_f32 v53, v186, v187
    v_cvt_pk_bf16_f32 v54, v188, v189
    v_cvt_pk_bf16_f32 v55, v190, v191
    v_lshlrev_b32 v56, 16, v52
    v_and_b32 v57, 0xffff0000, v52
    v_lshlrev_b32 v58, 16, v53
    v_and_b32 v59, 0xffff0000, v53
    v_lshlrev_b32 v60, 16, v54
    v_and_b32 v61, 0xffff0000, v54
    v_lshlrev_b32 v62, 16, v55
    v_and_b32 v63, 0xffff0000, v55
    v_pk_mul_f32 v[56:57], v[56:57], s[60:61]
    v_pk_mul_f32 v[58:59], v[58:59], s[60:61]
    v_pk_mul_f32 v[60:61], v[60:61], s[60:61]
    v_pk_mul_f32 v[62:63], v[62:63], s[60:61]
    v_cvt_pk_bf16_f32 v52, v56, v57
    v_cvt_pk_bf16_f32 v53, v58, v59
    v_cvt_pk_bf16_f32 v54, v60, v61
    v_cvt_pk_bf16_f32 v55, v62, v63
    v_lshlrev_b32 v56, 16, v52
    v_and_b32 v57, 0xffff0000, v52
    v_lshlrev_b32 v58, 16, v53
    v_and_b32 v59, 0xffff0000, v53
    v_lshlrev_b32 v60, 16, v54
    v_and_b32 v61, 0xffff0000, v54
    v_lshlrev_b32 v62, 16, v55
    v_and_b32 v63, 0xffff0000, v55
    v_pk_add_f32 v[56:57], v[56:57], v[46:47] op_sel_hi:[1,0] neg_lo:[0,1] neg_hi:[0,1]
    v_pk_add_f32 v[58:59], v[58:59], v[46:47] op_sel_hi:[1,0] neg_lo:[0,1] neg_hi:[0,1]
    v_pk_add_f32 v[60:61], v[60:61], v[46:47] op_sel_hi:[1,0] neg_lo:[0,1] neg_hi:[0,1]
    v_pk_add_f32 v[62:63], v[62:63], v[46:47] op_sel_hi:[1,0] neg_lo:[0,1] neg_hi:[0,1]
    v_pk_mul_f32 v[56:57], v[56:57], s[58:59]
    v_pk_mul_f32 v[58:59], v[58:59], s[58:59]
    v_pk_mul_f32 v[60:61], v[60:61], s[58:59]
    v_pk_mul_f32 v[62:63], v[62:63], s[58:59]
    v_exp_f32 v56, v56
    v_exp_f32 v57, v57
    v_exp_f32 v58, v58
    v_exp_f32 v59, v59
    v_exp_f32 v60, v60
    v_exp_f32 v61, v61
    v_exp_f32 v62, v62
    v_exp_f32 v63, v63
    v_cvt_pk_bf16_f32 v52, v56, v57
    v_cvt_pk_bf16_f32 v53, v58, v59
    v_cvt_pk_bf16_f32 v54, v60, v61
    v_cvt_pk_bf16_f32 v55, v62, v63
    v_pk_add_f32 v[56:57], v[56:57], v[58:59]
    v_pk_add_f32 v[60:61], v[60:61], v[62:63]
    v_pk_add_f32 v[48:49], v[48:49], v[56:57]
    v_pk_add_f32 v[48:49], v[48:49], v[60:61]
    ds_write_b128 v42, v[52:55] offset:4096
    s_waitcnt vmcnt(11)
    buffer_load_dwordx4 v50, s[20:23], s47 offen offset:1024 nt lds
    s_waitcnt vmcnt(11)
    buffer_load_dwordx4 v51, s[20:23], s47 offen offset:2048 nt lds
    s_waitcnt vmcnt(11)
    buffer_load_dwordx4 v22, s[20:23], s47 offen offset:3072 nt lds
    s_waitcnt vmcnt(8)
    s_waitcnt lgkmcnt(0)
    s_barrier
    ds_read_b128 v[112:115], v43 offset:4096
    ds_read_b64_tr_b16 v[96:97], v40 offset:49152
    ds_read_b64_tr_b16 v[98:99], v40 offset:51200
    ds_read_b128 v[116:119], v43 offset:5120
    ds_read_b64_tr_b16 v[100:101], v40 offset:53248
    ds_read_b64_tr_b16 v[102:103], v40 offset:55296
    ds_read_b128 v[120:123], v43 offset:6144
    ds_read_b64_tr_b16 v[104:105], v40 offset:57344
    ds_read_b64_tr_b16 v[106:107], v40 offset:59392
    ds_read_b128 v[124:127], v43 offset:7168
    ds_read_b64_tr_b16 v[108:109], v40 offset:61440
    ds_read_b64_tr_b16 v[110:111], v40 offset:63488
    v_and_b32 v92, 7, v0
    v_lshlrev_b32 v92, 2, v92
    buffer_load_dword v93, v92, s[28:31], s96 offen sc1
    s_waitcnt lgkmcnt(9)
    v_mfma_f32_32x32x16_bf16 v[64:79], v[96:99], v[112:115], v[64:79]
    s_waitcnt lgkmcnt(6)
    v_mfma_f32_32x32x16_bf16 v[64:79], v[100:103], v[116:119], v[64:79]
    s_waitcnt lgkmcnt(3)
    v_mfma_f32_32x32x16_bf16 v[64:79], v[104:107], v[120:123], v[64:79]
    s_waitcnt lgkmcnt(0)
    v_mfma_f32_32x32x16_bf16 v[64:79], v[108:111], v[124:127], v[64:79]
    s_waitcnt vmcnt(12)
    s_add_u32 m0, s41, 32768
    s_add_u32 s47, s40, 163840
    buffer_load_dwordx4 v20, s[20:23], s47 offen offset:0 nt lds
    v_cvt_pk_bf16_f32 v52, v192, v193
    v_cvt_pk_bf16_f32 v53, v194, v195
    v_cvt_pk_bf16_f32 v54, v196, v197
    v_cvt_pk_bf16_f32 v55, v198, v199
    v_lshlrev_b32 v56, 16, v52
    v_and_b32 v57, 0xffff0000, v52
    v_lshlrev_b32 v58, 16, v53
    v_and_b32 v59, 0xffff0000, v53
    v_lshlrev_b32 v60, 16, v54
    v_and_b32 v61, 0xffff0000, v54
    v_lshlrev_b32 v62, 16, v55
    v_and_b32 v63, 0xffff0000, v55
    v_pk_mul_f32 v[56:57], v[56:57], s[60:61]
    v_pk_mul_f32 v[58:59], v[58:59], s[60:61]
    v_pk_mul_f32 v[60:61], v[60:61], s[60:61]
    v_pk_mul_f32 v[62:63], v[62:63], s[60:61]
    v_cvt_pk_bf16_f32 v52, v56, v57
    v_cvt_pk_bf16_f32 v53, v58, v59
    v_cvt_pk_bf16_f32 v54, v60, v61
    v_cvt_pk_bf16_f32 v55, v62, v63
    v_lshlrev_b32 v56, 16, v52
    v_and_b32 v57, 0xffff0000, v52
    v_lshlrev_b32 v58, 16, v53
    v_and_b32 v59, 0xffff0000, v53
    v_lshlrev_b32 v60, 16, v54
    v_and_b32 v61, 0xffff0000, v54
    v_lshlrev_b32 v62, 16, v55
    v_and_b32 v63, 0xffff0000, v55
    v_pk_add_f32 v[56:57], v[56:57], v[46:47] op_sel_hi:[1,0] neg_lo:[0,1] neg_hi:[0,1]
    v_pk_add_f32 v[58:59], v[58:59], v[46:47] op_sel_hi:[1,0] neg_lo:[0,1] neg_hi:[0,1]
    v_pk_add_f32 v[60:61], v[60:61], v[46:47] op_sel_hi:[1,0] neg_lo:[0,1] neg_hi:[0,1]
    v_pk_add_f32 v[62:63], v[62:63], v[46:47] op_sel_hi:[1,0] neg_lo:[0,1] neg_hi:[0,1]
    v_pk_mul_f32 v[56:57], v[56:57], s[58:59]
    v_pk_mul_f32 v[58:59], v[58:59], s[58:59]
    v_pk_mul_f32 v[60:61], v[60:61], s[58:59]
    v_pk_mul_f32 v[62:63], v[62:63], s[58:59]
    v_exp_f32 v56, v56
    v_exp_f32 v57, v57
    v_exp_f32 v58, v58
    v_exp_f32 v59, v59
    v_exp_f32 v60, v60
    v_exp_f32 v61, v61
    v_exp_f32 v62, v62
    v_exp_f32 v63, v63
    v_cvt_pk_bf16_f32 v52, v56, v57
    v_cvt_pk_bf16_f32 v53, v58, v59
    v_cvt_pk_bf16_f32 v54, v60, v61
    v_cvt_pk_bf16_f32 v55, v62, v63
    v_pk_add_f32 v[56:57], v[56:57], v[58:59]
    v_pk_add_f32 v[60:61], v[60:61], v[62:63]
    v_pk_add_f32 v[48:49], v[48:49], v[56:57]
    v_pk_add_f32 v[48:49], v[48:49], v[60:61]
    ds_write_b128 v42, v[52:55] offset:0
    s_waitcnt vmcnt(12)
    buffer_load_dwordx4 v50, s[20:23], s47 offen offset:1024 nt lds
    s_waitcnt vmcnt(12)
    buffer_load_dwordx4 v51, s[20:23], s47 offen offset:2048 nt lds
    s_waitcnt vmcnt(12)
    buffer_load_dwordx4 v22, s[20:23], s47 offen offset:3072 nt lds
    s_waitcnt vmcnt(9)
    s_waitcnt lgkmcnt(0)
    s_barrier
    ds_read_b128 v[112:115], v43 offset:0
    ds_read_b64_tr_b16 v[96:97], v40 offset:0
    ds_read_b64_tr_b16 v[98:99], v40 offset:2048
    ds_read_b128 v[116:119], v43 offset:1024
    ds_read_b64_tr_b16 v[100:101], v40 offset:4096
    ds_read_b64_tr_b16 v[102:103], v40 offset:6144
    ds_read_b128 v[120:123], v43 offset:2048
    ds_read_b64_tr_b16 v[104:105], v40 offset:8192
    ds_read_b64_tr_b16 v[106:107], v40 offset:10240
    ds_read_b128 v[124:127], v43 offset:3072
    ds_read_b64_tr_b16 v[108:109], v40 offset:12288
    ds_read_b64_tr_b16 v[110:111], v40 offset:14336
    v_min_u32 v1, (L_code_end - L_ipf) / 128, v0
    v_lshlrev_b32 v1, 7, v1
    v_add_u32 v1, L_ipf - L_pc, v1
L_ipf:
    global_load_dword v47, v1, s[100:101]
    s_waitcnt lgkmcnt(9)
    v_mfma_f32_32x32x16_bf16 v[64:79], v[96:99], v[112:115], v[64:79]
    s_waitcnt lgkmcnt(6)
    v_mfma_f32_32x32x16_bf16 v[64:79], v[100:103], v[116:119], v[64:79]
    s_waitcnt lgkmcnt(3)
    v_mfma_f32_32x32x16_bf16 v[64:79], v[104:107], v[120:123], v[64:79]
    s_waitcnt lgkmcnt(0)
    v_mfma_f32_32x32x16_bf16 v[64:79], v[108:111], v[124:127], v[64:79]
    s_waitcnt vmcnt(13)
    s_add_u32 m0, s41, 49152
    s_add_u32 s47, s40, 180224
    buffer_load_dwordx4 v20, s[20:23], s47 offen offset:0 nt lds
    v_cvt_pk_bf16_f32 v52, v200, v201
    v_cvt_pk_bf16_f32 v53, v202, v203
    v_cvt_pk_bf16_f32 v54, v204, v205
    v_cvt_pk_bf16_f32 v55, v206, v207
    v_lshlrev_b32 v56, 16, v52
    v_and_b32 v57, 0xffff0000, v52
    v_lshlrev_b32 v58, 16, v53
    v_and_b32 v59, 0xffff0000, v53
    v_lshlrev_b32 v60, 16, v54
    v_and_b32 v61, 0xffff0000, v54
    v_lshlrev_b32 v62, 16, v55
    v_and_b32 v63, 0xffff0000, v55
    v_pk_mul_f32 v[56:57], v[56:57], s[60:61]
    v_pk_mul_f32 v[58:59], v[58:59], s[60:61]
    v_pk_mul_f32 v[60:61], v[60:61], s[60:61]
    v_pk_mul_f32 v[62:63], v[62:63], s[60:61]
    v_cvt_pk_bf16_f32 v52, v56, v57
    v_cvt_pk_bf16_f32 v53, v58, v59
    v_cvt_pk_bf16_f32 v54, v60, v61
    v_cvt_pk_bf16_f32 v55, v62, v63
    v_lshlrev_b32 v56, 16, v52
    v_and_b32 v57, 0xffff0000, v52
    v_lshlrev_b32 v58, 16, v53
    v_and_b32 v59, 0xffff0000, v53
    v_lshlrev_b32 v60, 16, v54
    v_and_b32 v61, 0xffff0000, v54
    v_lshlrev_b32 v62, 16, v55
    v_and_b32 v63, 0xffff0000, v55
    v_pk_add_f32 v[56:57], v[56:57], v[46:47] op_sel_hi:[1,0] neg_lo:[0,1] neg_hi:[0,1]
    v_pk_add_f32 v[58:59], v[58:59], v[46:47] op_sel_hi:[1,0] neg_lo:[0,1] neg_hi:[0,1]
    v_pk_add_f32 v[60:61], v[60:61], v[46:47] op_sel_hi:[1,0] neg_lo:[0,1] neg_hi:[0,1]
    v_pk_add_f32 v[62:63], v[62:63], v[46:47] op_sel_hi:[1,0] neg_lo:[0,1] neg_hi:[0,1]
    v_pk_mul_f32 v[56:57], v[56:57], s[58:59]
    v_pk_mul_f32 v[58:59], v[58:59], s[58:59]
    v_pk_mul_f32 v[60:61], v[60:61], s[58:59]
    v_pk_mul_f32 v[62:63], v[62:63], s[58:59]
    v_exp_f32 v56, v56
    v_exp_f32 v57, v57
    v_exp_f32 v58, v58
    v_exp_f32 v59, v59
    v_exp_f32 v60, v60
    v_exp_f32 v61, v61
    v_exp_f32 v62, v62
    v_exp_f32 v63, v63
    v_cvt_pk_bf16_f32 v52, v56, v57
    v_cvt_pk_bf16_f32 v53, v58, v59
    v_cvt_pk_bf16_f32 v54, v60, v61
    v_cvt_pk_bf16_f32 v55, v62, v63
    v_pk_add_f32 v[56:57], v[56:57], v[58:59]
    v_pk_add_f32 v[60:61], v[60:61], v[62:63]
    v_pk_add_f32 v[48:49], v[48:49], v[56:57]
    v_pk_add_f32 v[48:49], v[48:49], v[60:61]
    ds_write_b128 v42, v[52:55] offset:4096
    s_waitcnt vmcnt(13)
    buffer_load_dwordx4 v50, s[20:23], s47 offen offset:1024 nt lds
    s_waitcnt vmcnt(13)
    buffer_load_dwordx4 v51, s[20:23], s47 offen offset:2048 nt lds
    s_waitcnt vmcnt(13)
    buffer_load_dwordx4 v22, s[20:23], s47 offen offset:3072 nt lds
    s_waitcnt vmcnt(10)
    s_waitcnt lgkmcnt(0)
    s_barrier
    ds_read_b128 v[112:115], v43 offset:4096
    ds_read_b64_tr_b16 v[96:97], v40 offset:16384
    ds_read_b64_tr_b16 v[98:99], v40 offset:18432
    ds_read_b128 v[116:119], v43 offset:5120
    ds_read_b64_tr_b16 v[100:101], v40 offset:20480
    ds_read_b64_tr_b16 v[102:103], v40 offset:22528
    ds_read_b128 v[120:123], v43 offset:6144
    ds_read_b64_tr_b16 v[104:105], v40 offset:24576
    ds_read_b64_tr_b16 v[106:107], v40 offset:26624
    ds_read_b128 v[124:127], v43 offset:7168
    ds_read_b64_tr_b16 v[108:109], v40 offset:28672
    ds_read_b64_tr_b16 v[110:111], v40 offset:30720
    s_waitcnt lgkmcnt(9)
    v_mfma_f32_32x32x16_bf16 v[64:79], v[96:99], v[112:115], v[64:79]
    s_waitcnt lgkmcnt(6)
    v_mfma_f32_32x32x16_bf16 v[64:79], v[100:103], v[116:119], v[64:79]
    s_waitcnt lgkmcnt(3)
    v_mfma_f32_32x32x16_bf16 v[64:79], v[104:107], v[120:123], v[64:79]
    s_waitcnt lgkmcnt(0)
    v_mfma_f32_32x32x16_bf16 v[64:79], v[108:111], v[124:127], v[64:79]
    s_waitcnt vmcnt(13)
    s_add_u32 m0, s41, 0
    s_add_u32 s47, s40, 196608
    buffer_load_dwordx4 v20, s[20:23], s47 offen offset:0 nt lds
    v_cvt_pk_bf16_f32 v52, v208, v209
    v_cvt_pk_bf16_f32 v53, v210, v211
    v_cvt_pk_bf16_f32 v54, v212, v213
    v_cvt_pk_bf16_f32 v55, v214, v215
    v_lshlrev_b32 v56, 16, v52
    v_and_b32 v57, 0xffff0000, v52
    v_lshlrev_b32 v58, 16, v53
    v_and_b32 v59, 0xffff0000, v53
    v_lshlrev_b32 v60, 16, v54
    v_and_b32 v61, 0xffff0000, v54
    v_lshlrev_b32 v62, 16, v55
    v_and_b32 v63, 0xffff0000, v55
    v_pk_mul_f32 v[56:57], v[56:57], s[60:61]
    v_pk_mul_f32 v[58:59], v[58:59], s[60:61]
    v_pk_mul_f32 v[60:61], v[60:61], s[60:61]
    v_pk_mul_f32 v[62:63], v[62:63], s[60:61]
    v_cvt_pk_bf16_f32 v52, v56, v57
    v_cvt_pk_bf16_f32 v53, v58, v59
    v_cvt_pk_bf16_f32 v54, v60, v61
    v_cvt_pk_bf16_f32 v55, v62, v63
    v_lshlrev_b32 v56, 16, v52
    v_and_b32 v57, 0xffff0000, v52
    v_lshlrev_b32 v58, 16, v53
    v_and_b32 v59, 0xffff0000, v53
    v_lshlrev_b32 v60, 16, v54
    v_and_b32 v61, 0xffff0000, v54
    v_lshlrev_b32 v62, 16, v55
    v_and_b32 v63, 0xffff0000, v55
    v_pk_add_f32 v[56:57], v[56:57], v[46:47] op_sel_hi:[1,0] neg_lo:[0,1] neg_hi:[0,1]
    v_pk_add_f32 v[58:59], v[58:59], v[46:47] op_sel_hi:[1,0] neg_lo:[0,1] neg_hi:[0,1]
    v_pk_add_f32 v[60:61], v[60:61], v[46:47] op_sel_hi:[1,0] neg_lo:[0,1] neg_hi:[0,1]
    v_pk_add_f32 v[62:63], v[62:63], v[46:47] op_sel_hi:[1,0] neg_lo:[0,1] neg_hi:[0,1]
    v_pk_mul_f32 v[56:57], v[56:57], s[58:59]
    v_pk_mul_f32 v[58:59], v[58:59], s[58:59]
    v_pk_mul_f32 v[60:61], v[60:61], s[58:59]
    v_pk_mul_f32 v[62:63], v[62:63], s[58:59]
    v_exp_f32 v56, v56
    v_exp_f32 v57, v57
    v_exp_f32 v58, v58
    v_exp_f32 v59, v59
    v_exp_f32 v60, v60
    v_exp_f32 v61, v61
    v_exp_f32 v62, v62
    v_exp_f32 v63, v63
    v_cvt_pk_bf16_f32 v52, v56, v57
    v_cvt_pk_bf16_f32 v53, v58, v59
    v_cvt_pk_bf16_f32 v54, v60, v61
    v_cvt_pk_bf16_f32 v55, v62, v63
    v_pk_add_f32 v[56:57], v[56:57], v[58:59]
    v_pk_add_f32 v[60:61], v[60:61], v[62:63]
    v_pk_add_f32 v[48:49], v[48:49], v[56:57]
    v_pk_add_f32 v[48:49], v[48:49], v[60:61]
    ds_write_b128 v42, v[52:55] offset:0
    s_waitcnt vmcnt(13)
    buffer_load_dwordx4 v50, s[20:23], s47 offen offset:1024 nt lds
    s_waitcnt vmcnt(13)
    buffer_load_dwordx4 v51, s[20:23], s47 offen offset:2048 nt lds
    s_waitcnt vmcnt(13)
    buffer_load_dwordx4 v22, s[20:23], s47 offen offset:3072 nt lds
    s_waitcnt vmcnt(9)
    s_waitcnt lgkmcnt(0)
    s_barrier
    ds_read_b128 v[112:115], v43 offset:0
    ds_read_b64_tr_b16 v[96:97], v40 offset:32768
    ds_read_b64_tr_b16 v[98:99], v40 offset:34816
    ds_read_b128 v[116:119], v43 offset:1024
    ds_read_b64_tr_b16 v[100:101], v40 offset:36864
    ds_read_b64_tr_b16 v[102:103], v40 offset:38912
    ds_read_b128 v[120:123], v43 offset:2048
    ds_read_b64_tr_b16 v[104:105], v40 offset:40960
    ds_read_b64_tr_b16 v[106:107], v40 offset:43008
    ds_read_b128 v[124:127], v43 offset:3072
    ds_read_b64_tr_b16 v[108:109], v40 offset:45056
    ds_read_b64_tr_b16 v[110:111], v40 offset:47104
    s_waitcnt vmcnt(13)
    v_cmp_ne_u32 vcc, s49, v93
    s_cmp_eq_u64 vcc, 0
    s_cselect_b32 s97, 1, 0
    s_cselect_b32 s98, 0x10000000, 0
    s_waitcnt lgkmcnt(9)
    v_mfma_f32_32x32x16_bf16 v[64:79], v[96:99], v[112:115], v[64:79]
    s_waitcnt lgkmcnt(6)
    v_mfma_f32_32x32x16_bf16 v[64:79], v[100:103], v[116:119], v[64:79]
    s_waitcnt lgkmcnt(3)
    v_mfma_f32_32x32x16_bf16 v[64:79], v[104:107], v[120:123], v[64:79]
    s_waitcnt lgkmcnt(0)
    v_mfma_f32_32x32x16_bf16 v[64:79], v[108:111], v[124:127], v[64:79]
    s_waitcnt vmcnt(12)
    s_add_u32 m0, s41, 16384
    s_add_u32 s47, s40, 212992
    buffer_load_dwordx4 v20, s[20:23], s47 offen offset:0 nt lds
    v_cvt_pk_bf16_f32 v52, v216, v217
    v_cvt_pk_bf16_f32 v53, v218, v219
    v_cvt_pk_bf16_f32 v54, v220, v221
    v_cvt_pk_bf16_f32 v55, v222, v223
    v_lshlrev_b32 v56, 16, v52
    v_and_b32 v57, 0xffff0000, v52
    v_lshlrev_b32 v58, 16, v53
    v_and_b32 v59, 0xffff0000, v53
    v_lshlrev_b32 v60, 16, v54
    v_and_b32 v61, 0xffff0000, v54
    v_lshlrev_b32 v62, 16, v55
    v_and_b32 v63, 0xffff0000, v55
    v_pk_mul_f32 v[56:57], v[56:57], s[60:61]
    v_pk_mul_f32 v[58:59], v[58:59], s[60:61]
    v_pk_mul_f32 v[60:61], v[60:61], s[60:61]
    v_pk_mul_f32 v[62:63], v[62:63], s[60:61]
    v_cvt_pk_bf16_f32 v52, v56, v57
    v_cvt_pk_bf16_f32 v53, v58, v59
    v_cvt_pk_bf16_f32 v54, v60, v61
    v_cvt_pk_bf16_f32 v55, v62, v63
    v_lshlrev_b32 v56, 16, v52
    v_and_b32 v57, 0xffff0000, v52
    v_lshlrev_b32 v58, 16, v53
    v_and_b32 v59, 0xffff0000, v53
    v_lshlrev_b32 v60, 16, v54
    v_and_b32 v61, 0xffff0000, v54
    v_lshlrev_b32 v62, 16, v55
    v_and_b32 v63, 0xffff0000, v55
    v_pk_add_f32 v[56:57], v[56:57], v[46:47] op_sel_hi:[1,0] neg_lo:[0,1] neg_hi:[0,1]
    v_pk_add_f32 v[58:59], v[58:59], v[46:47] op_sel_hi:[1,0] neg_lo:[0,1] neg_hi:[0,1]
    v_pk_add_f32 v[60:61], v[60:61], v[46:47] op_sel_hi:[1,0] neg_lo:[0,1] neg_hi:[0,1]
    v_pk_add_f32 v[62:63], v[62:63], v[46:47] op_sel_hi:[1,0] neg_lo:[0,1] neg_hi:[0,1]
    v_pk_mul_f32 v[56:57], v[56:57], s[58:59]
    v_pk_mul_f32 v[58:59], v[58:59], s[58:59]
    v_pk_mul_f32 v[60:61], v[60:61], s[58:59]
    v_pk_mul_f32 v[62:63], v[62:63], s[58:59]
    v_exp_f32 v56, v56
    v_exp_f32 v57, v57
    v_exp_f32 v58, v58
    v_exp_f32 v59, v59
    v_exp_f32 v60, v60
    v_exp_f32 v61, v61
    v_exp_f32 v62, v62
    v_exp_f32 v63, v63
    v_cvt_pk_bf16_f32 v52, v56, v57
    v_cvt_pk_bf16_f32 v53, v58, v59
    v_cvt_pk_bf16_f32 v54, v60, v61
    v_cvt_pk_bf16_f32 v55, v62, v63
    v_pk_add_f32 v[56:57], v[56:57], v[58:59]
    v_pk_add_f32 v[60:61], v[60:61], v[62:63]
    v_pk_add_f32 v[48:49], v[48:49], v[56:57]
    v_pk_add_f32 v[48:49], v[48:49], v[60:61]
    ds_write_b128 v42, v[52:55] offset:4096
    s_waitcnt vmcnt(12)
    buffer_load_dwordx4 v50, s[20:23], s47 offen offset:1024 nt lds
    s_waitcnt vmcnt(12)
    buffer_load_dwordx4 v51, s[20:23], s47 offen offset:2048 nt lds
    s_waitcnt vmcnt(12)
    buffer_load_dwordx4 v22, s[20:23], s47 offen offset:3072 nt lds
    s_waitcnt vmcnt(8)
    s_waitcnt lgkmcnt(0)
    s_barrier
    ds_read_b128 v[112:115], v43 offset:4096
    ds_read_b64_tr_b16 v[96:97], v40 offset:49152
    ds_read_b64_tr_b16 v[98:99], v40 offset:51200
    ds_read_b128 v[116:119], v43 offset:5120
    ds_read_b64_tr_b16 v[100:101], v40 offset:53248
    ds_read_b64_tr_b16 v[102:103], v40 offset:55296
    ds_read_b128 v[120:123], v43 offset:6144
    ds_read_b64_tr_b16 v[104:105], v40 offset:57344
    ds_read_b64_tr_b16 v[106:107], v40 offset:59392
    ds_read_b128 v[124:127], v43 offset:7168
    ds_read_b64_tr_b16 v[108:109], v40 offset:61440
    ds_read_b64_tr_b16 v[110:111], v40 offset:63488
    s_waitcnt lgkmcnt(9)
    v_mfma_f32_32x32x16_bf16 v[64:79], v[96:99], v[112:115], v[64:79]
    s_waitcnt lgkmcnt(6)
    v_mfma_f32_32x32x16_bf16 v[64:79], v[100:103], v[116:119], v[64:79]
    s_waitcnt lgkmcnt(3)
    v_mfma_f32_32x32x16_bf16 v[64:79], v[104:107], v[120:123], v[64:79]
    s_waitcnt lgkmcnt(0)
    v_mfma_f32_32x32x16_bf16 v[64:79], v[108:111], v[124:127], v[64:79]
    s_waitcnt vmcnt(11)
    s_add_u32 m0, s41, 32768
    s_add_u32 s47, s40, 229376
    buffer_load_dwordx4 v20, s[20:23], s47 offen offset:0 nt lds
    v_cvt_pk_bf16_f32 v52, v224, v225
    v_cvt_pk_bf16_f32 v53, v226, v227
    v_cvt_pk_bf16_f32 v54, v228, v229
    v_cvt_pk_bf16_f32 v55, v230, v231
    v_lshlrev_b32 v56, 16, v52
    v_and_b32 v57, 0xffff0000, v52
    v_lshlrev_b32 v58, 16, v53
    v_and_b32 v59, 0xffff0000, v53
    v_lshlrev_b32 v60, 16, v54
    v_and_b32 v61, 0xffff0000, v54
    v_lshlrev_b32 v62, 16, v55
    v_and_b32 v63, 0xffff0000, v55
    v_pk_mul_f32 v[56:57], v[56:57], s[60:61]
    v_pk_mul_f32 v[58:59], v[58:59], s[60:61]
    v_pk_mul_f32 v[60:61], v[60:61], s[60:61]
    v_pk_mul_f32 v[62:63], v[62:63], s[60:61]
    v_cvt_pk_bf16_f32 v52, v56, v57
    v_cvt_pk_bf16_f32 v53, v58, v59
    v_cvt_pk_bf16_f32 v54, v60, v61
    v_cvt_pk_bf16_f32 v55, v62, v63
    v_lshlrev_b32 v56, 16, v52
    v_and_b32 v57, 0xffff0000, v52
    v_lshlrev_b32 v58, 16, v53
    v_and_b32 v59, 0xffff0000, v53
    v_lshlrev_b32 v60, 16, v54
    v_and_b32 v61, 0xffff0000, v54
    v_lshlrev_b32 v62, 16, v55
    v_and_b32 v63, 0xffff0000, v55
    v_pk_add_f32 v[56:57], v[56:57], v[46:47] op_sel_hi:[1,0] neg_lo:[0,1] neg_hi:[0,1]
    v_pk_add_f32 v[58:59], v[58:59], v[46:47] op_sel_hi:[1,0] neg_lo:[0,1] neg_hi:[0,1]
    v_pk_add_f32 v[60:61], v[60:61], v[46:47] op_sel_hi:[1,0] neg_lo:[0,1] neg_hi:[0,1]
    v_pk_add_f32 v[62:63], v[62:63], v[46:47] op_sel_hi:[1,0] neg_lo:[0,1] neg_hi:[0,1]
    v_pk_mul_f32 v[56:57], v[56:57], s[58:59]
    v_pk_mul_f32 v[58:59], v[58:59], s[58:59]
    v_pk_mul_f32 v[60:61], v[60:61], s[58:59]
    v_pk_mul_f32 v[62:63], v[62:63], s[58:59]
    v_exp_f32 v56, v56
    v_exp_f32 v57, v57
    v_exp_f32 v58, v58
    v_exp_f32 v59, v59
    v_exp_f32 v60, v60
    v_exp_f32 v61, v61
    v_exp_f32 v62, v62
    v_exp_f32 v63, v63
    v_cvt_pk_bf16_f32 v52, v56, v57
    v_cvt_pk_bf16_f32 v53, v58, v59
    v_cvt_pk_bf16_f32 v54, v60, v61
    v_cvt_pk_bf16_f32 v55, v62, v63
    v_pk_add_f32 v[56:57], v[56:57], v[58:59]
    v_pk_add_f32 v[60:61], v[60:61], v[62:63]
    v_pk_add_f32 v[48:49], v[48:49], v[56:57]
    v_pk_add_f32 v[48:49], v[48:49], v[60:61]
    ds_write_b128 v42, v[52:55] offset:0
    s_waitcnt vmcnt(11)
    buffer_load_dwordx4 v50, s[20:23], s47 offen offset:1024 nt lds
    s_waitcnt vmcnt(11)
    buffer_load_dwordx4 v51, s[20:23], s47 offen offset:2048 nt lds
    s_waitcnt vmcnt(11)
    buffer_load_dwordx4 v22, s[20:23], s47 offen offset:3072 nt lds
    s_waitcnt vmcnt(8)
    s_waitcnt lgkmcnt(0)
    s_barrier
    ds_read_b128 v[112:115], v43 offset:0
    ds_read_b64_tr_b16 v[96:97], v40 offset:0
    ds_read_b64_tr_b16 v[98:99], v40 offset:2048
    ds_read_b128 v[116:119], v43 offset:1024
    ds_read_b64_tr_b16 v[100:101], v40 offset:4096
    ds_read_b64_tr_b16 v[102:103], v40 offset:6144
    ds_read_b128 v[120:123], v43 offset:2048
    ds_read_b64_tr_b16 v[104:105], v40 offset:8192
    ds_read_b64_tr_b16 v[106:107], v40 offset:10240
    ds_read_b128 v[124:127], v43 offset:3072
    ds_read_b64_tr_b16 v[108:109], v40 offset:12288
    ds_read_b64_tr_b16 v[110:111], v40 offset:14336
    s_waitcnt lgkmcnt(9)
    v_mfma_f32_32x32x16_bf16 v[64:79], v[96:99], v[112:115], v[64:79]
    s_waitcnt lgkmcnt(6)
    v_mfma_f32_32x32x16_bf16 v[64:79], v[100:103], v[116:119], v[64:79]
    s_waitcnt lgkmcnt(3)
    v_mfma_f32_32x32x16_bf16 v[64:79], v[104:107], v[120:123], v[64:79]
    s_waitcnt lgkmcnt(0)
    v_mfma_f32_32x32x16_bf16 v[64:79], v[108:111], v[124:127], v[64:79]
    s_waitcnt vmcnt(11)
    s_add_u32 m0, s41, 49152
    s_add_u32 s47, s40, 245760
    buffer_load_dwordx4 v20, s[20:23], s47 offen offset:0 nt lds
    v_cvt_pk_bf16_f32 v52, v232, v233
    v_cvt_pk_bf16_f32 v53, v234, v235
    v_cvt_pk_bf16_f32 v54, v236, v237
    v_cvt_pk_bf16_f32 v55, v238, v239
    v_lshlrev_b32 v56, 16, v52
    v_and_b32 v57, 0xffff0000, v52
    v_lshlrev_b32 v58, 16, v53
    v_and_b32 v59, 0xffff0000, v53
    v_lshlrev_b32 v60, 16, v54
    v_and_b32 v61, 0xffff0000, v54
    v_lshlrev_b32 v62, 16, v55
    v_and_b32 v63, 0xffff0000, v55
    v_pk_mul_f32 v[56:57], v[56:57], s[60:61]
    v_pk_mul_f32 v[58:59], v[58:59], s[60:61]
    v_pk_mul_f32 v[60:61], v[60:61], s[60:61]
    v_pk_mul_f32 v[62:63], v[62:63], s[60:61]
    v_cvt_pk_bf16_f32 v52, v56, v57
    v_cvt_pk_bf16_f32 v53, v58, v59
    v_cvt_pk_bf16_f32 v54, v60, v61
    v_cvt_pk_bf16_f32 v55, v62, v63
    v_lshlrev_b32 v56, 16, v52
    v_and_b32 v57, 0xffff0000, v52
    v_lshlrev_b32 v58, 16, v53
    v_and_b32 v59, 0xffff0000, v53
    v_lshlrev_b32 v60, 16, v54
    v_and_b32 v61, 0xffff0000, v54
    v_lshlrev_b32 v62, 16, v55
    v_and_b32 v63, 0xffff0000, v55
    v_pk_add_f32 v[56:57], v[56:57], v[46:47] op_sel_hi:[1,0] neg_lo:[0,1] neg_hi:[0,1]
    v_pk_add_f32 v[58:59], v[58:59], v[46:47] op_sel_hi:[1,0] neg_lo:[0,1] neg_hi:[0,1]
    v_pk_add_f32 v[60:61], v[60:61], v[46:47] op_sel_hi:[1,0] neg_lo:[0,1] neg_hi:[0,1]
    v_pk_add_f32 v[62:63], v[62:63], v[46:47] op_sel_hi:[1,0] neg_lo:[0,1] neg_hi:[0,1]
    v_pk_mul_f32 v[56:57], v[56:57], s[58:59]
    v_pk_mul_f32 v[58:59], v[58:59], s[58:59]
    v_pk_mul_f32 v[60:61], v[60:61], s[58:59]
    v_pk_mul_f32 v[62:63], v[62:63], s[58:59]
    v_exp_f32 v56, v56
    v_exp_f32 v57, v57
    v_exp_f32 v58, v58
    v_exp_f32 v59, v59
    v_exp_f32 v60, v60
    v_exp_f32 v61, v61
    v_exp_f32 v62, v62
    v_exp_f32 v63, v63
    v_cvt_pk_bf16_f32 v52, v56, v57
    v_cvt_pk_bf16_f32 v53, v58, v59
    v_cvt_pk_bf16_f32 v54, v60, v61
    v_cvt_pk_bf16_f32 v55, v62, v63
    v_pk_add_f32 v[56:57], v[56:57], v[58:59]
    v_pk_add_f32 v[60:61], v[60:61], v[62:63]
    v_pk_add_f32 v[48:49], v[48:49], v[56:57]
    v_pk_add_f32 v[48:49], v[48:49], v[60:61]
    ds_write_b128 v42, v[52:55] offset:4096
    s_waitcnt vmcnt(11)
    buffer_load_dwordx4 v50, s[20:23], s47 offen offset:1024 nt lds
    s_waitcnt vmcnt(11)
    buffer_load_dwordx4 v51, s[20:23], s47 offen offset:2048 nt lds
    s_waitcnt vmcnt(11)
    buffer_load_dwordx4 v22, s[20:23], s47 offen offset:3072 nt lds
    s_waitcnt vmcnt(8)
    s_waitcnt lgkmcnt(0)
    s_barrier
    ds_read_b128 v[112:115], v43 offset:4096
    ds_read_b64_tr_b16 v[96:97], v40 offset:16384
    ds_read_b64_tr_b16 v[98:99], v40 offset:18432
    ds_read_b128 v[116:119], v43 offset:5120
    ds_read_b64_tr_b16 v[100:101], v40 offset:20480
    ds_read_b64_tr_b16 v[102:103], v40 offset:22528
    ds_read_b128 v[120:123], v43 offset:6144
    ds_read_b64_tr_b16 v[104:105], v40 offset:24576
    ds_read_b64_tr_b16 v[106:107], v40 offset:26624
    ds_read_b128 v[124:127], v43 offset:7168
    ds_read_b64_tr_b16 v[108:109], v40 offset:28672
    ds_read_b64_tr_b16 v[110:111], v40 offset:30720
    s_not_b64 exec, s[36:37]
    s_getreg_b32 s42, hwreg(HW_REG_XCC_ID, 0, 3)
    s_bitcmp1_b32 0xfa, s42
    s_cselect_b32 s30, s98, 0
    buffer_load_dwordx2 v[128:129], v11, s[28:31], s46 offen offset:2048
    buffer_load_dwordx4 v[132:135], v10, s[28:31], s46 offen
    buffer_load_dwordx4 v[136:139], v10, s[28:31], s46 offen offset:128
    s_mov_b64 exec, -1
    s_mov_b32 s30, 0x10000000
    s_waitcnt lgkmcnt(9)
    v_mfma_f32_32x32x16_bf16 v[64:79], v[96:99], v[112:115], v[64:79]
    s_waitcnt lgkmcnt(6)
    v_mfma_f32_32x32x16_bf16 v[64:79], v[100:103], v[116:119], v[64:79]
    s_waitcnt lgkmcnt(3)
    v_mfma_f32_32x32x16_bf16 v[64:79], v[104:107], v[120:123], v[64:79]
    s_waitcnt lgkmcnt(0)
    v_mfma_f32_32x32x16_bf16 v[64:79], v[108:111], v[124:127], v[64:79]
    v_cvt_pk_bf16_f32 v52, v240, v241
    v_cvt_pk_bf16_f32 v53, v242, v243
    v_cvt_pk_bf16_f32 v54, v244, v245
    v_cvt_pk_bf16_f32 v55, v246, v247
    v_lshlrev_b32 v56, 16, v52
    v_and_b32 v57, 0xffff0000, v52
    v_lshlrev_b32 v58, 16, v53
    v_and_b32 v59, 0xffff0000, v53
    v_lshlrev_b32 v60, 16, v54
    v_and_b32 v61, 0xffff0000, v54
    v_lshlrev_b32 v62, 16, v55
    v_and_b32 v63, 0xffff0000, v55
    v_pk_mul_f32 v[56:57], v[56:57], s[60:61]
    v_pk_mul_f32 v[58:59], v[58:59], s[60:61]
    v_pk_mul_f32 v[60:61], v[60:61], s[60:61]
    v_pk_mul_f32 v[62:63], v[62:63], s[60:61]
    v_cvt_pk_bf16_f32 v52, v56, v57
    v_cvt_pk_bf16_f32 v53, v58, v59
    v_cvt_pk_bf16_f32 v54, v60, v61
    v_cvt_pk_bf16_f32 v55, v62, v63
    v_lshlrev_b32 v56, 16, v52
    v_and_b32 v57, 0xffff0000, v52
    v_lshlrev_b32 v58, 16, v53
    v_and_b32 v59, 0xffff0000, v53
    v_lshlrev_b32 v60, 16, v54
    v_and_b32 v61, 0xffff0000, v54
    v_lshlrev_b32 v62, 16, v55
    v_and_b32 v63, 0xffff0000, v55
    v_pk_add_f32 v[56:57], v[56:57], v[46:47] op_sel_hi:[1,0] neg_lo:[0,1] neg_hi:[0,1]
    v_pk_add_f32 v[58:59], v[58:59], v[46:47] op_sel_hi:[1,0] neg_lo:[0,1] neg_hi:[0,1]
    v_pk_add_f32 v[60:61], v[60:61], v[46:47] op_sel_hi:[1,0] neg_lo:[0,1] neg_hi:[0,1]
    v_pk_add_f32 v[62:63], v[62:63], v[46:47] op_sel_hi:[1,0] neg_lo:[0,1] neg_hi:[0,1]
    v_pk_mul_f32 v[56:57], v[56:57], s[58:59]
    v_pk_mul_f32 v[58:59], v[58:59], s[58:59]
    v_pk_mul_f32 v[60:61], v[60:61], s[58:59]
    v_pk_mul_f32 v[62:63], v[62:63], s[58:59]
    v_exp_f32 v56, v56
    v_exp_f32 v57, v57
    v_exp_f32 v58, v58
    v_exp_f32 v59, v59
    v_exp_f32 v60, v60
    v_exp_f32 v61, v61
    v_exp_f32 v62, v62
    v_exp_f32 v63, v63
    v_cvt_pk_bf16_f32 v52, v56, v57
    v_cvt_pk_bf16_f32 v53, v58, v59
    v_cvt_pk_bf16_f32 v54, v60, v61
    v_cvt_pk_bf16_f32 v55, v62, v63
    v_pk_add_f32 v[56:57], v[56:57], v[58:59]
    v_pk_add_f32 v[60:61], v[60:61], v[62:63]
    v_pk_add_f32 v[48:49], v[48:49], v[56:57]
    v_pk_add_f32 v[48:49], v[48:49], v[60:61]
    ds_write_b128 v42, v[52:55] offset:0
    s_waitcnt vmcnt(7)
    s_waitcnt lgkmcnt(0)
    s_barrier
    ds_read_b128 v[112:115], v43 offset:0
    ds_read_b64_tr_b16 v[96:97], v40 offset:32768
    ds_read_b64_tr_b16 v[98:99], v40 offset:34816
    ds_read_b128 v[116:119], v43 offset:1024
    ds_read_b64_tr_b16 v[100:101], v40 offset:36864
    ds_read_b64_tr_b16 v[102:103], v40 offset:38912
    ds_read_b128 v[120:123], v43 offset:2048
    ds_read_b64_tr_b16 v[104:105], v40 offset:40960
    ds_read_b64_tr_b16 v[106:107], v40 offset:43008
    ds_read_b128 v[124:127], v43 offset:3072
    ds_read_b64_tr_b16 v[108:109], v40 offset:45056
    ds_read_b64_tr_b16 v[110:111], v40 offset:47104
    s_waitcnt lgkmcnt(9)
    v_mfma_f32_32x32x16_bf16 v[64:79], v[96:99], v[112:115], v[64:79]
    s_waitcnt lgkmcnt(6)
    v_mfma_f32_32x32x16_bf16 v[64:79], v[100:103], v[116:119], v[64:79]
    s_waitcnt lgkmcnt(3)
    v_mfma_f32_32x32x16_bf16 v[64:79], v[104:107], v[120:123], v[64:79]
    s_waitcnt lgkmcnt(0)
    v_mfma_f32_32x32x16_bf16 v[64:79], v[108:111], v[124:127], v[64:79]
    v_cvt_pk_bf16_f32 v52, v248, v249
    v_cvt_pk_bf16_f32 v53, v250, v251
    v_cvt_pk_bf16_f32 v54, v252, v253
    v_cvt_pk_bf16_f32 v55, v254, v255
    v_lshlrev_b32 v56, 16, v52
    v_and_b32 v57, 0xffff0000, v52
    v_lshlrev_b32 v58, 16, v53
    v_and_b32 v59, 0xffff0000, v53
    v_lshlrev_b32 v60, 16, v54
    v_and_b32 v61, 0xffff0000, v54
    v_lshlrev_b32 v62, 16, v55
    v_and_b32 v63, 0xffff0000, v55
    v_pk_mul_f32 v[56:57], v[56:57], s[60:61]
    v_pk_mul_f32 v[58:59], v[58:59], s[60:61]
    v_pk_mul_f32 v[60:61], v[60:61], s[60:61]
    v_pk_mul_f32 v[62:63], v[62:63], s[60:61]
    v_cvt_pk_bf16_f32 v52, v56, v57
    v_cvt_pk_bf16_f32 v53, v58, v59
    v_cvt_pk_bf16_f32 v54, v60, v61
    v_cvt_pk_bf16_f32 v55, v62, v63
    v_lshlrev_b32 v56, 16, v52
    v_and_b32 v57, 0xffff0000, v52
    v_lshlrev_b32 v58, 16, v53
    v_and_b32 v59, 0xffff0000, v53
    v_lshlrev_b32 v60, 16, v54
    v_and_b32 v61, 0xffff0000, v54
    v_lshlrev_b32 v62, 16, v55
    v_and_b32 v63, 0xffff0000, v55
    v_pk_add_f32 v[56:57], v[56:57], v[46:47] op_sel_hi:[1,0] neg_lo:[0,1] neg_hi:[0,1]
    v_pk_add_f32 v[58:59], v[58:59], v[46:47] op_sel_hi:[1,0] neg_lo:[0,1] neg_hi:[0,1]
    v_pk_add_f32 v[60:61], v[60:61], v[46:47] op_sel_hi:[1,0] neg_lo:[0,1] neg_hi:[0,1]
    v_pk_add_f32 v[62:63], v[62:63], v[46:47] op_sel_hi:[1,0] neg_lo:[0,1] neg_hi:[0,1]
    v_pk_mul_f32 v[56:57], v[56:57], s[58:59]
    v_pk_mul_f32 v[58:59], v[58:59], s[58:59]
    v_pk_mul_f32 v[60:61], v[60:61], s[58:59]
    v_pk_mul_f32 v[62:63], v[62:63], s[58:59]
    v_exp_f32 v56, v56
    v_exp_f32 v57, v57
    v_exp_f32 v58, v58
    v_exp_f32 v59, v59
    v_exp_f32 v60, v60
    v_exp_f32 v61, v61
    v_exp_f32 v62, v62
    v_exp_f32 v63, v63
    v_cvt_pk_bf16_f32 v52, v56, v57
    v_cvt_pk_bf16_f32 v53, v58, v59
    v_cvt_pk_bf16_f32 v54, v60, v61
    v_cvt_pk_bf16_f32 v55, v62, v63
    v_pk_add_f32 v[56:57], v[56:57], v[58:59]
    v_pk_add_f32 v[60:61], v[60:61], v[62:63]
    v_pk_add_f32 v[48:49], v[48:49], v[56:57]
    v_pk_add_f32 v[48:49], v[48:49], v[60:61]
    ds_write_b128 v42, v[52:55] offset:4096
    v_add_f32 v48, v48, v49
    v_mov_b32 v1, v48
    s_nop 1
    v_permlane32_swap_b32 v1, v48
    v_add_f32 v1, v1, v48
    ds_write_b32 v44, v1 offset:512
    s_waitcnt vmcnt(3)
    s_waitcnt lgkmcnt(0)
    s_barrier
    ds_read_b128 v[112:115], v43 offset:4096
    ds_read_b64_tr_b16 v[96:97], v40 offset:49152
    ds_read_b64_tr_b16 v[98:99], v40 offset:51200
    ds_read_b128 v[116:119], v43 offset:5120
    ds_read_b64_tr_b16 v[100:101], v40 offset:53248
    ds_read_b64_tr_b16 v[102:103], v40 offset:55296
    ds_read_b128 v[120:123], v43 offset:6144
    ds_read_b64_tr_b16 v[104:105], v40 offset:57344
    ds_read_b64_tr_b16 v[106:107], v40 offset:59392
    ds_read_b128 v[124:127], v43 offset:7168
    ds_read_b64_tr_b16 v[108:109], v40 offset:61440
    ds_read_b64_tr_b16 v[110:111], v40 offset:63488
    ds_read_b128 v[4:7], v45 offset:512
    s_waitcnt lgkmcnt(10)
    v_mfma_f32_32x32x16_bf16 v[64:79], v[96:99], v[112:115], v[64:79]
    s_waitcnt lgkmcnt(7)
    v_mfma_f32_32x32x16_bf16 v[64:79], v[100:103], v[116:119], v[64:79]
    s_waitcnt lgkmcnt(4)
    v_mfma_f32_32x32x16_bf16 v[64:79], v[104:107], v[120:123], v[64:79]
    s_waitcnt lgkmcnt(1)
    v_mfma_f32_32x32x16_bf16 v[64:79], v[108:111], v[124:127], v[64:79]
    s_waitcnt lgkmcnt(0)
    v_add_f32 v4, v4, v5
    v_add_f32 v6, v6, v7
    v_add_f32 v3, v4, v6
    v_cndmask_b32 v88, v46, v3, s[38:39]
    v_xor_b32 v89, s54, v88
    s_cmp_eq_u32 s97, 1
    s_nop 4
    s_cbranch_scc0 L_pub_far
    v_cvt_pk_bf16_f32 v80, v64, v65
    v_cvt_pk_bf16_f32 v81, v66, v67
    v_cvt_pk_bf16_f32 v82, v68, v69
    v_cvt_pk_bf16_f32 v83, v70, v71
    v_xor_b32 v80, s62, v80
    buffer_store_dwordx4 v[80:83], v8, s[28:31], s50 offen
    v_cvt_pk_bf16_f32 v84, v72, v73
    v_cvt_pk_bf16_f32 v85, v74, v75
    v_cvt_pk_bf16_f32 v86, v76, v77
    v_cvt_pk_bf16_f32 v87, v78, v79
    v_xor_b32 v84, s63, v84
    buffer_store_dwordx4 v[84:87], v8, s[28:31], s50 offen offset:128
    v_bitop3_b32 v89, v89, v80, v81 bitop3:0x96
    v_bitop3_b32 v89, v89, v82, v83 bitop3:0x96
    v_bitop3_b32 v89, v89, v84, v85 bitop3:0x96
    v_bitop3_b32 v89, v89, v86, v87 bitop3:0x96
    buffer_store_dwordx2 v[88:89], v9, s[28:31], s51 offen offset:2048
L_pub_done:
    s_not_b64 exec, s[36:37]
    buffer_load_dwordx2 v[104:105], v11, s[28:31], s46 offen offset:2048 sc1
    buffer_load_dwordx4 v[96:99], v10, s[28:31], s46 offen sc1
    buffer_load_dwordx4 v[100:103], v10, s[28:31], s46 offen offset:128 sc1
    s_mov_b64 exec, -1
    ds_write_b128 v12, v[80:83]
    ds_write_b128 v12, v[84:87] offset:1024
    ds_write_b64 v13, v[88:89] offset:2048
    s_mov_b64 exec, s[36:37]
    s_waitcnt lgkmcnt(0)
    ds_read_b128 v[96:99], v14
    ds_read_b128 v[100:103], v14 offset:1024
    ds_read_b64 v[104:105], v15 offset:2048
    s_not_b64 exec, exec
    s_branch L_poll_chk
L_poll:
    buffer_load_dwordx2 v[104:105], v11, s[28:31], s46 offen offset:2048 sc1
    buffer_load_dwordx4 v[96:99], v10, s[28:31], s46 offen sc1
    buffer_load_dwordx4 v[100:103], v10, s[28:31], s46 offen offset:128 sc1
    s_sub_u32 s55, s55, 1
    s_cbranch_scc1 L_poll_done
L_poll_chk:
    s_waitcnt vmcnt(2)
    v_bitop3_b32 v1, v104, v105, s54 bitop3:0x96
    s_waitcnt vmcnt(1)
    v_bitop3_b32 v1, v1, v96, v97 bitop3:0x96
    v_bitop3_b32 v1, v1, v98, v99 bitop3:0x96
    s_waitcnt vmcnt(0)
    v_bitop3_b32 v1, v1, v100, v101 bitop3:0x96
    v_bitop3_b32 v1, v1, v102, v103 bitop3:0x96
    s_nop 1
    v_or_b32_dpp v1, v1, v1 quad_perm:[1,0,3,2] row_mask:0xf bank_mask:0xf
    v_cmp_ne_u32 vcc, 0, v1
    s_and_b64 exec, exec, vcc
    s_cbranch_execnz L_poll
L_poll_done:
    s_mov_b64 exec, -1
    s_waitcnt vmcnt(0) lgkmcnt(0)
    v_mov_b32_dpp v1, v104 quad_perm:[0,0,2,2] row_mask:0xf bank_mask:0xf
    v_mov_b32_dpp v2, v104 quad_perm:[1,1,3,3] row_mask:0xf bank_mask:0xf
    v_xor_b32 v96, s62, v96
    v_max_f32_dpp v3, v1, v1 row_ror:8 row_mask:0xf bank_mask:0xf
    v_xor_b32 v100, s63, v100
    v_mov_b32 v4, v3
    v_lshlrev_b32 v112, 16, v96
    v_and_b32 v113, 0xffff0000, v96
    v_lshlrev_b32 v114, 16, v97
    v_and_b32 v115, 0xffff0000, v97
    v_permlane16_swap_b32 v3, v4
    v_max_f32 v3, v3, v4
    v_mov_b32 v4, v3
    v_lshlrev_b32 v116, 16, v98
    v_and_b32 v117, 0xffff0000, v98
    v_permlane32_swap_b32 v3, v4
    v_max_f32 v3, v3, v4
    v_sub_f32 v1, v1, v3
    v_mul_f32 v1, s58, v1
    v_exp_f32 v6, v1
    v_lshlrev_b32 v118, 16, v99
    v_mul_f32 v2, v2, v6
    v_and_b32 v119, 0xffff0000, v99
    v_lshlrev_b32 v120, 16, v100
    v_add_f32_dpp v3, v2, v2 row_ror:8 row_mask:0xf bank_mask:0xf
    v_and_b32 v121, 0xffff0000, v100
    v_mov_b32 v4, v3
    v_lshlrev_b32 v122, 16, v101
    v_and_b32 v123, 0xffff0000, v101
    v_permlane16_swap_b32 v3, v4
    v_add_f32 v3, v3, v4
    v_mov_b32 v4, v3
    v_lshlrev_b32 v124, 16, v102
    v_and_b32 v125, 0xffff0000, v102
    v_permlane32_swap_b32 v3, v4
    v_add_f32 v3, v3, v4
    v_rcp_f32 v3, v3
    v_lshlrev_b32 v126, 16, v103
    v_and_b32 v127, 0xffff0000, v103
    v_pk_mul_f32 v[112:113], v[112:113], v[6:7] op_sel_hi:[1,0]
    v_pk_mul_f32 v[114:115], v[114:115], v[6:7] op_sel_hi:[1,0]
    v_pk_mul_f32 v[116:117], v[116:117], v[6:7] op_sel_hi:[1,0]
    v_pk_mul_f32 v[118:119], v[118:119], v[6:7] op_sel_hi:[1,0]
    v_pk_mul_f32 v[120:121], v[120:121], v[6:7] op_sel_hi:[1,0]
    v_pk_mul_f32 v[122:123], v[122:123], v[6:7] op_sel_hi:[1,0]
    v_pk_mul_f32 v[124:125], v[124:125], v[6:7] op_sel_hi:[1,0]
    v_pk_mul_f32 v[126:127], v[126:127], v[6:7] op_sel_hi:[1,0]
    s_nop 0
    v_permlane32_swap_b32 v112, v120
    v_permlane32_swap_b32 v113, v121
    v_permlane32_swap_b32 v114, v122
    v_permlane32_swap_b32 v115, v123
    v_permlane32_swap_b32 v116, v124
    v_permlane32_swap_b32 v117, v125
    v_permlane32_swap_b32 v118, v126
    v_permlane32_swap_b32 v119, v127
    v_pk_add_f32 v[112:113], v[112:113], v[120:121]
    v_pk_add_f32 v[114:115], v[114:115], v[122:123]
    v_pk_add_f32 v[116:117], v[116:117], v[124:125]
    v_pk_add_f32 v[118:119], v[118:119], v[126:127]
    s_nop 0
    v_permlane16_swap_b32 v112, v116
    v_permlane16_swap_b32 v113, v117
    v_permlane16_swap_b32 v114, v118
    v_permlane16_swap_b32 v115, v119
    v_pk_add_f32 v[112:113], v[112:113], v[116:117]
    v_pk_add_f32 v[114:115], v[114:115], v[118:119]
    s_nop 0
    v_add_f32_dpp v116, v112, v112 row_ror:8 row_mask:0xf bank_mask:0xf
    v_add_f32_dpp v117, v113, v113 row_ror:8 row_mask:0xf bank_mask:0xf
    v_add_f32_dpp v118, v114, v114 row_ror:8 row_mask:0xf bank_mask:0xf
    v_add_f32_dpp v119, v115, v115 row_ror:8 row_mask:0xf bank_mask:0xf
    v_cndmask_b32 v116, v116, v118, s[56:57]
    v_cndmask_b32 v117, v117, v119, s[56:57]
    v_mul_f32 v116, v116, v3
    v_mul_f32 v117, v117, v3
    v_cvt_pk_bf16_f32 v1, v116, v117
    buffer_store_dword v1, v23, s[32:35], s48 offen
    s_or_b32 s42, s45, s3
    s_cbranch_scc1 L_end
    v_mov_b32 v2, s52
    v_mov_b32 v3, 0
    s_mov_b64 exec, 1
    buffer_store_dword v2, v3, s[28:31], s53 offen
L_end:
    s_endpgm
L_pub_far:
    v_cvt_pk_bf16_f32 v80, v64, v65
    v_cvt_pk_bf16_f32 v81, v66, v67
    v_cvt_pk_bf16_f32 v82, v68, v69
    v_cvt_pk_bf16_f32 v83, v70, v71
    v_xor_b32 v80, s62, v80
    buffer_store_dwordx4 v[80:83], v8, s[28:31], s50 offen sc1
    v_cvt_pk_bf16_f32 v84, v72, v73
    v_cvt_pk_bf16_f32 v85, v74, v75
    v_cvt_pk_bf16_f32 v86, v76, v77
    v_cvt_pk_bf16_f32 v87, v78, v79
    v_xor_b32 v84, s63, v84
    buffer_store_dwordx4 v[84:87], v8, s[28:31], s50 offen offset:128 sc1
    v_bitop3_b32 v89, v89, v80, v81 bitop3:0x96
    v_bitop3_b32 v89, v89, v82, v83 bitop3:0x96
    v_bitop3_b32 v89, v89, v84, v85 bitop3:0x96
    v_bitop3_b32 v89, v89, v86, v87 bitop3:0x96
    buffer_store_dwordx2 v[88:89], v9, s[28:31], s51 offen offset:2048 sc1
    s_branch L_pub_done
L_code_end:
    s_endpgm
.section .rodata,"a"
.p2align 6
.amdhsa_kernel standalone__gqa_softmax__sampling_kernel
  .amdhsa_next_free_vgpr 256
  .amdhsa_next_free_sgpr 102
  .amdhsa_accum_offset 256
  .amdhsa_group_segment_fixed_size 0
  .amdhsa_kernarg_size 48
  .amdhsa_user_sgpr_count 2
  .amdhsa_user_sgpr_kernarg_segment_ptr 1
  .amdhsa_system_sgpr_workgroup_id_x 1
  .amdhsa_float_denorm_mode_32 3
.end_amdhsa_kernel
```
